```python
import torch

def _softmax(x, axis=-1):
    return torch.softmax(x, dim=axis)
def _gelu(x):
    return torch.nn.functional.gelu(x, approximate="tanh")
def _silu(x):
    return torch.nn.functional.silu(x)
def _sigmoid(x):
    return torch.sigmoid(x)
def _layernorm(x, axis=-1, eps=1e-5):
    m = x.mean(dim=axis, keepdim=True)
    v = x.var(dim=axis, keepdim=True, unbiased=False)
    return (x - m) / torch.sqrt(v + eps)
def _scatter_add(tgt, idx, src, axis=0):
    return tgt.clone().index_add_(axis, idx, src)
def _segment_sum(src, seg, n):
    out = torch.zeros((n,) + src.shape[1:], dtype=src.dtype)
    return out.index_add_(0, seg, src)
def _pad(x, pw):
    flat = tuple(v for pair in reversed(pw) for v in pair)
    return torch.nn.functional.pad(x, flat)

kernel_name = 'gated_mix__softmax_full_mha__ssm_conv_s4d__prompt'

def setup_inputs():

    _w = (lambda a: (lambda t: t.to(torch.bfloat16) if t.is_floating_point() else t)(torch.as_tensor(a)))
    def _A_setup():
        B, S, D = 1, 2048, 512
        return {
            "x": _w((lambda *s: torch.randn(*s, dtype=torch.bfloat16) * 0.05)(B, S, D)),
            "wqkv": _w((lambda *s: torch.randn(*s, dtype=torch.bfloat16) * 0.8)(D, 3 * D)),
            "wo": _w((lambda *s: torch.randn(*s, dtype=torch.bfloat16) * 0.05)(D, D)),
        }
    _A_in = _A_setup()

    def _B_setup():
        Bsz, L, D, N = 1, 2048, 512, 128
        return {
            "u": _w((lambda *s: torch.randn(*s, dtype=torch.bfloat16) * 0.05)(Bsz, L, D)),
            "log_A_real": _w((lambda *s: torch.randn(*s, dtype=torch.bfloat16) * 6.4)(D, N) * 0.5),
            "A_imag": _w((lambda *s: torch.randn(*s, dtype=torch.bfloat16) * 0.1)(D, N) * 3.14),
            "C_real": _w((lambda *s: torch.randn(*s, dtype=torch.bfloat16) * 0.4)(D, N) / N ** 0.5),
            "C_imag": _w((lambda *s: torch.randn(*s, dtype=torch.bfloat16) * 0.4)(D, N) / N ** 0.5),
            "log_dt": _w((lambda *s: torch.randn(*s, dtype=torch.bfloat16) * 0.1)(D) * 0.5 - 4.0),
            "D_skip": _w((lambda *s: torch.randn(*s, dtype=torch.bfloat16) * 0.1)(D)),
        }
    _B_in = _B_setup()

    return {
        "A_x": _A_in["x"],
        "A_wqkv": _A_in["wqkv"],
        "A_wo": _A_in["wo"],
        "B_u": _B_in["u"],
        "B_log_A_real": _B_in["log_A_real"],
        "B_A_imag": _B_in["A_imag"],
        "B_C_real": _B_in["C_real"],
        "B_C_imag": _B_in["C_imag"],
        "B_log_dt": _B_in["log_dt"],
        "B_D_skip": _B_in["D_skip"],
        "gate_w": _w((lambda *s: torch.randn(*s, dtype=torch.bfloat16) * 0.05)(512) * 16.0),
    }

def reference(A_x, A_wqkv, A_wo, B_u, B_log_A_real, B_A_imag, B_C_real, B_C_imag, B_log_dt, B_D_skip, gate_w):
    def _A_ref(x, wqkv, wo):
        B, S, D = x.shape
        H = 32; Dh = D // H
        qkv = (lambda x, *d: x.permute(*d))((x @ wqkv).reshape(B, S, 3, H, Dh), 2, 0, 3, 1, 4)
        q, k, v = qkv[0], qkv[1], qkv[2]
        scale = Dh ** -0.5
        scores = torch.einsum("bhqd,bhkd->bhqk", q, k) * scale
        p = _softmax(scores, axis=-1)
        o = torch.einsum("bhqk,bhkd->bhqd", p, v)
        return (lambda x, *d: x.permute(*d))(o, 0, 2, 1, 3).reshape(B, S, D) @ wo

    def _B_ref(u, log_A_real, A_imag, C_real, C_imag, log_dt, D_skip):
        L = u.shape[1]
        dt = torch.exp(log_dt)
        A = -torch.exp(log_A_real) + 1j * A_imag
        C = (C_real + 1j * C_imag) * dt[:, None]
        pos = (lambda x, dt: x.to(dt))(torch.arange(L), log_dt.dtype)
        P = torch.exp((A * dt[:, None])[:, :, None] * pos[None, None, :])
        K = 2.0 * torch.einsum("dn,dnl->dl", C, P).real
        L2 = 2 * L
        u_t = (lambda x, *d: x.permute(*d))(u, 0, 2, 1)
        Kf = (lambda x, *a, **k: torch.fft.rfft(x.float(), *a, **k))(K, L2)
        Uf = (lambda x, *a, **k: torch.fft.rfft(x.float(), *a, **k))(u_t, L2)
        y = (lambda x, *a, **k: torch.fft.irfft(x, *a, **k).to(torch.bfloat16))(Uf * Kf[None, :, :], L2)[:, :, :L]
        y = (lambda x, *d: x.permute(*d))(y, 0, 2, 1)
        return y + u * D_skip[None, None, :]

    x = A_x
    g = _sigmoid((x * gate_w).sum(-1, keepdims=True))
    a = _A_ref(x, A_wqkv, A_wo)
    b = _B_ref(x, B_log_A_real, B_A_imag, B_C_real, B_C_imag, B_log_dt, B_D_skip)
    return g * a + (1 - g) * b
```

```asm
; @launch grid=(256,1,1) block=(512,1,1) lds=163840
.amdgcn_target "amdgcn-amd-amdhsa--gfx950"
.text
.globl gated_mix__softmax_full_mha__ssm_conv_s4d__prompt_kernel
.p2align 8
.type gated_mix__softmax_full_mha__ssm_conv_s4d__prompt_kernel,@function
gated_mix__softmax_full_mha__ssm_conv_s4d__prompt_kernel:
    s_cmp_ge_u32 s2, 256
    s_cbranch_scc1 L_end
    s_load_dwordx16 s[4:19], s[0:1], 0
    s_load_dwordx8 s[20:27], s[0:1], 64
    s_load_dwordx4 s[28:31], s[0:1], 96
    s_getpc_b64 s[62:63]
L_pc0:
    v_lshrrev_b32 v1, 6, v0
    v_and_b32 v2, 7, v0
    v_lshlrev_b32 v2, 7, v2
    v_lshl_add_u32 v2, v1, 10, v2
    s_lshr_b32 s64, s2, 3
    s_and_b32 s64, s64, 3
    s_lshl_b32 s64, s64, 13
    v_add_u32 v2, s64, v2
    v_min_u32 v2, L_codeend - L_pc0 - 4, v2
    v_mov_b32 v5, s63
    v_add_co_u32 v4, vcc, s62, v2
    s_nop 1
    v_addc_co_u32 v5, vcc, 0, v5, vcc
    s_mov_b64 exec, 0xff
    global_load_dword v93, v[4:5], off
    s_mov_b64 exec, -1
    v_and_b32 v0, 63, v0
    v_readfirstlane_b32 s50, v1
    s_and_b32 s48, s2, 7
    s_lshr_b32 s49, s2, 3
    s_mov_b32 s42, 33554432
    s_mov_b32 s43, 0x20000
    s_cmp_lt_u32 s50, 4
    s_cbranch_scc1 L_gemm
    s_and_b32 s51, s50, 3
    s_lshr_b32 s52, s51, 1
    s_and_b32 s53, s51, 1
    s_lshl_b32 s54, s48, 6
    s_lshl_b32 s55, s49, 1
    s_add_u32 s54, s54, s55
    s_add_u32 s54, s54, s52
    s_lshl_b32 s55, s54, 8
    s_lshl_b32 s56, s53, 7
    s_add_u32 s55, s55, s56
    v_lshlrev_b32 v1, 1, v0
    v_add_u32 v1, s55, v1
    s_lshl_b32 s56, s54, 1
    v_mov_b32 v2, s56
    s_waitcnt lgkmcnt(0)
    global_load_short_d16_hi v10, v1, s[12:13]
    global_load_short_d16_hi v14, v2, s[20:21]
    global_load_short_d16_hi v11, v1, s[14:15]
    global_load_short_d16_hi v12, v1, s[16:17]
    global_load_short_d16_hi v13, v1, s[18:19]
    global_load_short_d16_hi v90, v2, s[22:23]
    s_mov_b32 s40, s30
    s_mov_b32 s41, s31
    v_mov_b32 v242, 0
    s_mov_b32 s56, 13172736
    buffer_load_dword v240, v242, s[40:43], s56 offen sc1
    s_barrier
    s_branch L_aux
L_gemm:
    v_lshrrev_b32 v1, 3, v0
    v_lshrrev_b32 v2, 4, v0
    s_and_b32 s58, s50, 1
    s_lshl_b32 s56, s58, 2
    v_add_u32 v3, s56, v2
    v_and_b32 v95, 7, v0
    v_xor_b32 v3, v3, v95
    v_lshlrev_b32 v3, 4, v3
    v_lshl_add_u32 v94, v1, 10, v3
    v_and_b32 v2, 1, v2
    v_lshlrev_b32 v2, 2, v2
    v_xor_b32 v2, v2, v95
    v_lshlrev_b32 v2, 4, v2
    v_mov_b32 v3, 0xc00
    v_mad_u32_u24 v95, v1, v3, v2
    s_lshl_b32 s44, s49, 16
    s_lshl_b32 s45, s50, 13
    s_add_u32 s44, s44, s45
    s_mul_i32 s45, s50, 49152
    s_lshl_b32 s56, s48, 7
    s_add_u32 s45, s45, s56
    s_lshl_b32 s46, s50, 10
    s_lshl_b32 s47, s50, 11
    s_mul_i32 s54, s49, 37
    s_lshr_b32 s54, s54, 8
    s_mul_i32 s54, s54, 7
    s_sub_u32 s54, s49, s54
    s_mov_b32 s34, 0x200000
    s_mov_b32 s35, 0x20000
    s_mov_b32 s38, 0x180000
    s_mov_b32 s39, 0x20000
    s_waitcnt lgkmcnt(0)
    s_mov_b32 s32, s4
    s_mov_b32 s33, s5
    s_mov_b32 s36, s6
    s_mov_b32 s37, s7
    s_mov_b32 s40, s30
    s_mov_b32 s41, s31
    s_barrier
    s_add_u32 m0, s46, 65536
    s_add_u32 s56, s48, 0
    s_and_b32 s56, s56, 7
    s_lshl_b32 s57, s56, 7
    s_add_u32 s57, s57, s44
    buffer_load_dwordx4 v94, s[32:35], s57 offen  lds
    s_add_u32 m0, s46, 69632
    s_add_u32 s57, s57, 0x8000
    buffer_load_dwordx4 v94, s[32:35], s57 offen  lds
    s_add_u32 m0, s47, 73728
    s_mul_i32 s56, s56, 196608
    s_add_u32 s56, s56, s45
    buffer_load_dwordx4 v95, s[36:39], s56 offen offset:0  lds
    s_add_u32 m0, s47, 80896
    s_nop 0
    buffer_load_dwordx4 v95, s[36:39], s56 offen offset:1024  lds
    s_add_u32 m0, s47, 88064
    s_nop 0
    buffer_load_dwordx4 v95, s[36:39], s56 offen offset:2048  lds
    s_add_u32 m0, s47, 74752
    s_add_u32 s56, s56, 24576
    buffer_load_dwordx4 v95, s[36:39], s56 offen offset:0  lds
    s_add_u32 m0, s47, 81920
    s_nop 0
    buffer_load_dwordx4 v95, s[36:39], s56 offen offset:1024  lds
    s_add_u32 m0, s47, 89088
    s_nop 0
    buffer_load_dwordx4 v95, s[36:39], s56 offen offset:2048  lds
    s_add_u32 m0, s46, 98304
    s_add_u32 s56, s54, 0
    s_cmp_ge_u32 s56, 7
    s_cselect_b32 s57, 6, -1
    s_sub_u32 s56, s56, s57
    s_add_u32 s56, s56, s48
    s_and_b32 s56, s56, 7
    s_lshl_b32 s57, s56, 7
    s_add_u32 s57, s57, s44
    buffer_load_dwordx4 v94, s[32:35], s57 offen  lds
    s_add_u32 m0, s46, 102400
    s_add_u32 s57, s57, 0x8000
    buffer_load_dwordx4 v94, s[32:35], s57 offen  lds
    s_add_u32 m0, s47, 106496
    s_mul_i32 s56, s56, 196608
    s_add_u32 s56, s56, s45
    buffer_load_dwordx4 v95, s[36:39], s56 offen offset:0  lds
    s_add_u32 m0, s47, 113664
    s_nop 0
    buffer_load_dwordx4 v95, s[36:39], s56 offen offset:1024  lds
    s_add_u32 m0, s47, 120832
    s_nop 0
    buffer_load_dwordx4 v95, s[36:39], s56 offen offset:2048  lds
    s_add_u32 m0, s47, 107520
    s_add_u32 s56, s56, 24576
    buffer_load_dwordx4 v95, s[36:39], s56 offen offset:0  lds
    s_add_u32 m0, s47, 114688
    s_nop 0
    buffer_load_dwordx4 v95, s[36:39], s56 offen offset:1024  lds
    s_add_u32 m0, s47, 121856
    s_nop 0
    buffer_load_dwordx4 v95, s[36:39], s56 offen offset:2048  lds
    s_getreg_b32 s62, hwreg(HW_REG_XCC_ID)
    v_mov_b32 v241, s62
    s_lshr_b32 s59, s50, 1
    v_and_b32 v1, 31, v0
    s_lshl_b32 s60, s58, 12
    s_add_u32 s60, s60, 32768
    v_lshlrev_b32 v2, 7, v1
    v_add_u32 v2, s60, v2
    v_bfe_u32 v1, v0, 1, 3
    v_lshrrev_b32 v3, 5, v0
    v_xor_b32 v1, v1, v3
    v_xor_b32 v3, 0, v1
    v_lshl_add_u32 v4, v3, 4, v2
    v_add_u32 v8, 0x10000, v4
    v_xor_b32 v3, 2, v1
    v_lshl_add_u32 v5, v3, 4, v2
    v_add_u32 v9, 0x10000, v5
    v_xor_b32 v3, 4, v1
    v_lshl_add_u32 v6, v3, 4, v2
    v_add_u32 v10, 0x10000, v6
    v_xor_b32 v3, 6, v1
    v_lshl_add_u32 v7, v3, 4, v2
    v_add_u32 v11, 0x10000, v7
    v_lshrrev_b32 v1, 5, v0
    v_lshlrev_b32 v1, 10, v1
    v_bfe_u32 v2, v0, 2, 2
    v_lshl_add_u32 v1, v2, 7, v1
    v_bfe_u32 v2, v0, 3, 1
    v_xor_b32 v2, s59, v2
    v_lshl_add_u32 v1, v2, 6, v1
    v_bfe_u32 v2, v0, 4, 1
    v_lshl_add_u32 v1, v2, 5, v1
    v_and_b32 v2, 3, v0
    v_lshl_add_u32 v1, v2, 3, v1
    v_add_u32 v12, 40960, v1
    v_add_u32 v13, 106496, v1
    v_mov_b32 v242, 0
    s_mov_b32 s56, 13172736
    buffer_load_dword v240, v242, s[40:43], s56 offen sc1
    s_add_u32 m0, s46, 131072
    s_add_u32 s56, s54, 1
    s_cmp_ge_u32 s56, 7
    s_cselect_b32 s57, 6, -1
    s_sub_u32 s56, s56, s57
    s_add_u32 s56, s56, s48
    s_and_b32 s56, s56, 7
    s_lshl_b32 s57, s56, 7
    s_add_u32 s57, s57, s44
    buffer_load_dwordx4 v94, s[32:35], s57 offen  lds
    s_add_u32 m0, s46, 135168
    s_add_u32 s57, s57, 0x8000
    buffer_load_dwordx4 v94, s[32:35], s57 offen  lds
    s_add_u32 m0, s47, 139264
    s_mul_i32 s56, s56, 196608
    s_add_u32 s56, s56, s45
    buffer_load_dwordx4 v95, s[36:39], s56 offen offset:0  lds
    s_add_u32 m0, s47, 146432
    s_nop 0
    buffer_load_dwordx4 v95, s[36:39], s56 offen offset:1024  lds
    s_add_u32 m0, s47, 153600
    s_nop 0
    buffer_load_dwordx4 v95, s[36:39], s56 offen offset:2048  lds
    s_add_u32 m0, s47, 140288
    s_add_u32 s56, s56, 24576
    buffer_load_dwordx4 v95, s[36:39], s56 offen offset:0  lds
    s_add_u32 m0, s47, 147456
    s_nop 0
    buffer_load_dwordx4 v95, s[36:39], s56 offen offset:1024  lds
    s_add_u32 m0, s47, 154624
    s_nop 0
    buffer_load_dwordx4 v95, s[36:39], s56 offen offset:2048  lds
    s_add_u32 m0, s47, 40960
    s_add_u32 s56, s54, 2
    s_cmp_ge_u32 s56, 7
    s_cselect_b32 s57, 6, -1
    s_sub_u32 s56, s56, s57
    s_add_u32 s56, s56, s48
    s_and_b32 s56, s56, 7
    s_mul_i32 s56, s56, 196608
    s_add_u32 s56, s56, s45
    buffer_load_dwordx4 v95, s[36:39], s56 offen offset:0  lds
    s_add_u32 m0, s47, 48128
    s_nop 0
    buffer_load_dwordx4 v95, s[36:39], s56 offen offset:1024  lds
    s_add_u32 m0, s47, 55296
    s_nop 0
    buffer_load_dwordx4 v95, s[36:39], s56 offen offset:2048  lds
    s_add_u32 m0, s47, 41984
    s_add_u32 s56, s56, 24576
    buffer_load_dwordx4 v95, s[36:39], s56 offen offset:0  lds
    s_add_u32 m0, s47, 49152
    s_nop 0
    buffer_load_dwordx4 v95, s[36:39], s56 offen offset:1024  lds
    s_add_u32 m0, s47, 56320
    s_nop 0
    buffer_load_dwordx4 v95, s[36:39], s56 offen offset:2048  lds
    s_waitcnt vmcnt(23)
    s_barrier
    ds_read_b128 v[144:147], v4 offset:32768
    ds_read_b64_tr_b16 v[152:153], v12 offset:40960
    ds_read_b64_tr_b16 v[154:155], v12 offset:41472
    ds_read_b64_tr_b16 v[156:157], v12 offset:49152
    ds_read_b64_tr_b16 v[158:159], v12 offset:49664
    ds_read_b64_tr_b16 v[148:149], v12 offset:32768
    ds_read_b64_tr_b16 v[150:151], v12 offset:33280
    ds_read_b128 v[160:163], v5 offset:32768
    ds_read_b64_tr_b16 v[168:169], v12 offset:43008
    ds_read_b64_tr_b16 v[170:171], v12 offset:43520
    ds_read_b64_tr_b16 v[172:173], v12 offset:51200
    ds_read_b64_tr_b16 v[174:175], v12 offset:51712
    ds_read_b64_tr_b16 v[164:165], v12 offset:34816
    ds_read_b64_tr_b16 v[166:167], v12 offset:35328
    s_waitcnt lgkmcnt(7)
    v_mfma_f32_32x32x16_bf16 v[112:127], v[152:155], v[144:147], 0
    ds_read_b128 v[176:179], v6 offset:32768
    ds_read_b64_tr_b16 v[184:185], v12 offset:45056
    ds_read_b64_tr_b16 v[186:187], v12 offset:45568
    ds_read_b64_tr_b16 v[188:189], v12 offset:53248
    s_lshl_b32 s67, s49, 6
    s_lshl_b32 s62, s48, 3
    s_add_u32 s67, s67, s62
    v_mfma_f32_32x32x16_bf16 v[128:143], v[144:147], v[156:159], 0
    ds_read_b64_tr_b16 v[190:191], v12 offset:53760
    ds_read_b64_tr_b16 v[180:181], v12 offset:36864
    ds_read_b64_tr_b16 v[182:183], v12 offset:37376
    s_lshl_b32 s62, s50, 1
    s_add_u32 s67, s67, s62
    v_lshlrev_b32 v15, 4, v0
    v_mfma_f32_32x32x16_bf16 v[96:111], v[148:151], v[144:147], 0
    s_lshl_b32 s62, s67, 10
    v_add_u32 v14, s62, v15
    s_lshl_b32 s62, s48, 5
    s_add_u32 s62, s62, s49
    s_lshr_b32 s69, s62, 3
    s_waitcnt lgkmcnt(7)
    v_mfma_f32_32x32x16_bf16 v[112:127], v[168:171], v[160:163], v[112:127]
    ds_read_b128 v[192:195], v7 offset:32768
    ds_read_b64_tr_b16 v[200:201], v12 offset:47104
    ds_read_b64_tr_b16 v[202:203], v12 offset:47616
    ds_read_b64_tr_b16 v[204:205], v12 offset:55296
    s_and_b32 s63, s62, 7
    s_lshl_b32 s63, s63, 1
    s_add_u32 s63, s63, s58
    v_mfma_f32_32x32x16_bf16 v[128:143], v[160:163], v[172:175], v[128:143]
    ds_read_b64_tr_b16 v[206:207], v12 offset:55808
    ds_read_b64_tr_b16 v[196:197], v12 offset:38912
    ds_read_b64_tr_b16 v[198:199], v12 offset:39424
    s_lshl_b32 s64, s63, 15
    s_lshl_b32 s62, s69, 5
    s_add_u32 s64, s64, s62
    v_mfma_f32_32x32x16_bf16 v[96:111], v[164:167], v[160:163], v[96:111]
    v_lshrrev_b32 v3, 5, v0
    v_lshlrev_b32 v3, 14, v3
    v_bfe_u32 v2, v0, 4, 1
    v_lshl_add_u32 v3, v2, 12, v3
    v_and_b32 v2, 15, v0
    s_waitcnt lgkmcnt(0)
    s_waitcnt vmcnt(15)
    s_barrier
    v_mfma_f32_32x32x16_bf16 v[112:127], v[184:187], v[176:179], v[112:127]
    ds_read_b128 v[144:147], v8 offset:0
    ds_read_b64_tr_b16 v[152:153], v13 offset:8192
    ds_read_b64_tr_b16 v[154:155], v13 offset:8704
    ds_read_b64_tr_b16 v[156:157], v13 offset:16384
    v_lshl_add_u32 v3, v2, 1, v3
    v_add_u32 v52, s64, v3
    v_add_u32 v57, 0x2000, v52
    v_mfma_f32_32x32x16_bf16 v[128:143], v[176:179], v[188:191], v[128:143]
    ds_read_b64_tr_b16 v[158:159], v13 offset:16896
    ds_read_b64_tr_b16 v[148:149], v13 offset:0
    ds_read_b64_tr_b16 v[150:151], v13 offset:512
    s_lshl_b32 s69, s69, 4
    s_add_u32 s69, s69, s63
    s_lshl_b32 s69, s69, 10
    v_mfma_f32_32x32x16_bf16 v[96:111], v[180:183], v[176:179], v[96:111]
    s_add_u32 s69, s69, 12582912
    s_lshl_b32 s67, s67, 2
    s_add_u32 s67, s67, 13107200
    s_lshl_b32 s72, s48, 2
    s_add_u32 s72, s72, s50
    s_add_u32 m0, s46, 32768
    s_add_u32 s56, s54, 2
    s_cmp_ge_u32 s56, 7
    s_cselect_b32 s57, 6, -1
    s_sub_u32 s56, s56, s57
    s_add_u32 s56, s56, s48
    s_and_b32 s56, s56, 7
    s_lshl_b32 s57, s56, 7
    s_add_u32 s57, s57, s44
    buffer_load_dwordx4 v94, s[32:35], s57 offen  lds
    s_add_u32 m0, s46, 36864
    s_add_u32 s57, s57, 0x8000
    buffer_load_dwordx4 v94, s[32:35], s57 offen  lds
    s_add_u32 m0, s46, 65536
    s_add_u32 s56, s54, 3
    s_cmp_ge_u32 s56, 7
    s_cselect_b32 s57, 6, -1
    s_sub_u32 s56, s56, s57
    s_add_u32 s56, s56, s48
    s_and_b32 s56, s56, 7
    s_lshl_b32 s57, s56, 7
    s_add_u32 s57, s57, s44
    buffer_load_dwordx4 v94, s[32:35], s57 offen  lds
    v_mfma_f32_32x32x16_bf16 v[112:127], v[200:203], v[192:195], v[112:127]
    ds_read_b128 v[160:163], v9 offset:0
    ds_read_b64_tr_b16 v[168:169], v13 offset:10240
    ds_read_b64_tr_b16 v[170:171], v13 offset:10752
    ds_read_b64_tr_b16 v[172:173], v13 offset:18432
    s_lshl_b32 s72, s72, 8
    s_add_u32 s72, s72, 13176832
    v_and_b32 v53, 31, v0
    v_mfma_f32_32x32x16_bf16 v[128:143], v[192:195], v[204:207], v[128:143]
    ds_read_b64_tr_b16 v[174:175], v13 offset:18944
    ds_read_b64_tr_b16 v[164:165], v13 offset:2048
    ds_read_b64_tr_b16 v[166:167], v13 offset:2560
    v_lshlrev_b32 v53, 3, v53
    s_lshl_b32 s70, s48, 1
    s_lshr_b32 s71, s49, 4
    v_mfma_f32_32x32x16_bf16 v[96:111], v[196:199], v[192:195], v[96:111]
    s_add_u32 s71, s71, s70
    s_lshl_b32 s71, s71, 8
    s_add_u32 s71, s71, 13185024
    s_add_u32 s70, s70, s59
    s_lshl_b32 s70, s70, 8
    s_add_u32 m0, s46, 69632
    s_add_u32 s57, s57, 0x8000
    buffer_load_dwordx4 v94, s[32:35], s57 offen  lds
    s_add_u32 m0, s47, 73728
    s_mul_i32 s56, s56, 196608
    s_add_u32 s56, s56, s45
    buffer_load_dwordx4 v95, s[36:39], s56 offen offset:0  lds
    s_add_u32 m0, s47, 80896
    s_nop 0
    buffer_load_dwordx4 v95, s[36:39], s56 offen offset:1024  lds
    s_waitcnt lgkmcnt(7)
    v_mfma_f32_32x32x16_bf16 v[112:127], v[152:155], v[144:147], v[112:127]
    ds_read_b128 v[176:179], v10 offset:0
    ds_read_b64_tr_b16 v[184:185], v13 offset:12288
    ds_read_b64_tr_b16 v[186:187], v13 offset:12800
    ds_read_b64_tr_b16 v[188:189], v13 offset:20480
    s_lshl_b32 s62, s49, 3
    s_add_u32 s70, s70, s62
    s_lshl_b32 s62, s58, 2
    v_mfma_f32_32x32x16_bf16 v[128:143], v[144:147], v[156:159], v[128:143]
    ds_read_b64_tr_b16 v[190:191], v13 offset:20992
    ds_read_b64_tr_b16 v[180:181], v13 offset:4096
    ds_read_b64_tr_b16 v[182:183], v13 offset:4608
    s_add_u32 s70, s70, s62
    s_add_u32 s70, s70, 13185024
    v_lshlrev_b32 v54, 2, v0
    v_mfma_f32_32x32x16_bf16 v[96:111], v[148:151], v[144:147], v[96:111]
    s_lshl_b32 s60, s48, 2
    s_lshl_b32 s61, s59, 1
    s_add_u32 s60, s60, s61
    s_lshl_b32 s60, s60, 6
    s_lshl_b32 s61, s49, 1
    s_add_u32 m0, s47, 88064
    s_nop 0
    buffer_load_dwordx4 v95, s[36:39], s56 offen offset:2048  lds
    s_add_u32 m0, s47, 74752
    s_add_u32 s56, s56, 24576
    buffer_load_dwordx4 v95, s[36:39], s56 offen offset:0  lds
    s_add_u32 m0, s47, 81920
    s_nop 0
    buffer_load_dwordx4 v95, s[36:39], s56 offen offset:1024  lds
    s_waitcnt lgkmcnt(7)
    v_mfma_f32_32x32x16_bf16 v[112:127], v[168:171], v[160:163], v[112:127]
    ds_read_b128 v[192:195], v11 offset:0
    ds_read_b64_tr_b16 v[200:201], v13 offset:14336
    ds_read_b64_tr_b16 v[202:203], v13 offset:14848
    ds_read_b64_tr_b16 v[204:205], v13 offset:22528
    s_add_u32 s61, s61, s58
    s_add_u32 s60, s60, s61
    s_lshl_b32 s61, s60, 10
    v_mfma_f32_32x32x16_bf16 v[128:143], v[160:163], v[172:175], v[128:143]
    ds_read_b64_tr_b16 v[206:207], v13 offset:23040
    ds_read_b64_tr_b16 v[196:197], v13 offset:6144
    ds_read_b64_tr_b16 v[198:199], v13 offset:6656
    s_add_u32 s61, s61, 0
    s_add_u32 s62, s61, 0x10000
    s_lshl_b32 s63, s60, 11
    v_mfma_f32_32x32x16_bf16 v[96:111], v[164:167], v[160:163], v[96:111]
    s_add_u32 s63, s63, 2097152
    s_add_u32 s64, s63, 0x20000
    s_mov_b32 s65, 1052289595
    v_and_b32 v55, 0x33, v0
    v_bfe_u32 v3, v0, 2, 1
    s_add_u32 m0, s47, 89088
    s_nop 0
    buffer_load_dwordx4 v95, s[36:39], s56 offen offset:2048  lds
    s_waitcnt lgkmcnt(0)
    s_waitcnt vmcnt(16)
    s_barrier
    v_mfma_f32_32x32x16_bf16 v[112:127], v[184:187], v[176:179], v[112:127]
    ds_read_b128 v[144:147], v8 offset:32768
    ds_read_b64_tr_b16 v[152:153], v13 offset:40960
    ds_read_b64_tr_b16 v[154:155], v13 offset:41472
    ds_read_b64_tr_b16 v[156:157], v13 offset:49152
    v_lshl_or_b32 v55, v3, 3, v55
    v_bfe_u32 v3, v0, 3, 1
    v_lshl_or_b32 v55, v3, 2, v55
    v_mfma_f32_32x32x16_bf16 v[128:143], v[176:179], v[188:191], v[128:143]
    ds_read_b64_tr_b16 v[158:159], v13 offset:49664
    ds_read_b64_tr_b16 v[148:149], v13 offset:32768
    ds_read_b64_tr_b16 v[150:151], v13 offset:33280
    v_lshlrev_b32 v55, 4, v55
    v_and_b32 v56, 15, v0
    v_lshlrev_b32 v56, 4, v56
    v_mfma_f32_32x32x16_bf16 v[96:111], v[180:183], v[176:179], v[96:111]
    v_lshrrev_b32 v3, 5, v0
    v_lshl_add_u32 v56, v3, 8, v56
    v_bfe_u32 v3, v0, 4, 1
    v_lshl_add_u32 v56, v3, 17, v56
    v_mov_b32 v232, 0
    s_add_u32 m0, s46, 98304
    s_add_u32 s56, s54, 4
    s_cmp_ge_u32 s56, 7
    s_cselect_b32 s57, 6, -1
    s_sub_u32 s56, s56, s57
    s_add_u32 s56, s56, s48
    s_and_b32 s56, s56, 7
    s_lshl_b32 s57, s56, 7
    s_add_u32 s57, s57, s44
    buffer_load_dwordx4 v94, s[32:35], s57 offen  lds
    s_add_u32 m0, s46, 102400
    s_add_u32 s57, s57, 0x8000
    buffer_load_dwordx4 v94, s[32:35], s57 offen  lds
    v_mfma_f32_32x32x16_bf16 v[112:127], v[200:203], v[192:195], v[112:127]
    ds_read_b128 v[160:163], v9 offset:32768
    ds_read_b64_tr_b16 v[168:169], v13 offset:43008
    ds_read_b64_tr_b16 v[170:171], v13 offset:43520
    ds_read_b64_tr_b16 v[172:173], v13 offset:51200
    v_mov_b32 v233, 0
    v_mov_b32 v234, 0
    v_mov_b32 v235, 0
    v_mfma_f32_32x32x16_bf16 v[128:143], v[192:195], v[204:207], v[128:143]
    ds_read_b64_tr_b16 v[174:175], v13 offset:51712
    ds_read_b64_tr_b16 v[164:165], v13 offset:34816
    ds_read_b64_tr_b16 v[166:167], v13 offset:35328
    s_lshr_b32 s74, s49, 3
    s_lshl_b32 s75, s48, 2
    s_add_u32 s74, s74, s75
    v_mfma_f32_32x32x16_bf16 v[96:111], v[196:199], v[192:195], v[96:111]
    s_and_b32 s75, s49, 7
    s_lshl_b32 s76, s75, 3
    s_add_u32 s76, s76, s50
    s_lshl_b32 s77, s74, 6
    s_add_u32 s77, s77, s76
    s_add_u32 m0, s47, 106496
    s_mul_i32 s56, s56, 196608
    s_add_u32 s56, s56, s45
    buffer_load_dwordx4 v95, s[36:39], s56 offen offset:0  lds
    s_add_u32 m0, s47, 113664
    s_nop 0
    buffer_load_dwordx4 v95, s[36:39], s56 offen offset:1024  lds
    s_waitcnt lgkmcnt(7)
    v_mfma_f32_32x32x16_bf16 v[112:127], v[152:155], v[144:147], v[112:127]
    ds_read_b128 v[176:179], v10 offset:32768
    ds_read_b64_tr_b16 v[184:185], v13 offset:45056
    ds_read_b64_tr_b16 v[186:187], v13 offset:45568
    ds_read_b64_tr_b16 v[188:189], v13 offset:53248
    s_lshl_b32 s77, s77, 10
    s_add_u32 s77, s77, 0
    s_lshl_b32 s78, s74, 17
    v_mfma_f32_32x32x16_bf16 v[128:143], v[144:147], v[156:159], v[128:143]
    ds_read_b64_tr_b16 v[190:191], v13 offset:53760
    ds_read_b64_tr_b16 v[180:181], v13 offset:36864
    ds_read_b64_tr_b16 v[182:183], v13 offset:37376
    s_lshl_b32 s79, s50, 10
    s_add_u32 s78, s78, s79
    s_add_u32 s78, s78, 2097152
    v_mfma_f32_32x32x16_bf16 v[96:111], v[148:151], v[144:147], v[96:111]
    s_mov_b32 s82, 0xffff
    s_mov_b32 s83, 0xffff
    v_and_b32 v16, 27, v0
    v_cmp_eq_u32 vcc, 16, v16
    v_mov_b32 v17, 0x3f803f80
    s_add_u32 m0, s47, 120832
    s_nop 0
    buffer_load_dwordx4 v95, s[36:39], s56 offen offset:2048  lds
    s_add_u32 m0, s47, 107520
    s_add_u32 s56, s56, 24576
    buffer_load_dwordx4 v95, s[36:39], s56 offen offset:0  lds
    s_waitcnt lgkmcnt(7)
    v_mfma_f32_32x32x16_bf16 v[112:127], v[168:171], v[160:163], v[112:127]
    ds_read_b128 v[192:195], v11 offset:32768
    ds_read_b64_tr_b16 v[200:201], v13 offset:47104
    ds_read_b64_tr_b16 v[202:203], v13 offset:47616
    ds_read_b64_tr_b16 v[204:205], v13 offset:55296
    v_mov_b32 v92, 163836
    v_cndmask_b32 v16, 0, v17, vcc
    v_mov_b32 v93, 1
    v_mfma_f32_32x32x16_bf16 v[128:143], v[160:163], v[172:175], v[128:143]
    ds_read_b64_tr_b16 v[206:207], v13 offset:55808
    ds_read_b64_tr_b16 v[196:197], v13 offset:38912
    ds_read_b64_tr_b16 v[198:199], v13 offset:39424
    v_mov_b32 v17, v16
    v_mov_b32 v18, v16
    v_mov_b32 v19, v16
    v_mfma_f32_32x32x16_bf16 v[96:111], v[164:167], v[160:163], v[96:111]
    v_mov_b32 v20, v16
    v_mov_b32 v21, v16
    v_mov_b32 v22, v16
    v_mov_b32 v23, v16
    v_mov_b32 v24, v16
    s_add_u32 m0, s47, 114688
    s_nop 0
    buffer_load_dwordx4 v95, s[36:39], s56 offen offset:1024  lds
    s_add_u32 m0, s47, 121856
    s_nop 0
    buffer_load_dwordx4 v95, s[36:39], s56 offen offset:2048  lds
    s_waitcnt lgkmcnt(0)
    s_waitcnt vmcnt(16)
    s_mov_b32 s55, 1664525
    v_mul_lo_u32 v240, v240, s55
    v_add_u32 v240, 1013904223, v240
    s_barrier
    v_mfma_f32_32x32x16_bf16 v[112:127], v[184:187], v[176:179], v[112:127]
    ds_read_b128 v[144:147], v4 offset:0
    ds_read_b64_tr_b16 v[152:153], v12 offset:8192
    ds_read_b64_tr_b16 v[154:155], v12 offset:8704
    ds_read_b64_tr_b16 v[156:157], v12 offset:16384
    v_mov_b32 v25, v16
    v_mov_b32 v26, v16
    v_mov_b32 v27, v16
    v_mfma_f32_32x32x16_bf16 v[128:143], v[176:179], v[188:191], v[128:143]
    ds_read_b64_tr_b16 v[158:159], v12 offset:16896
    ds_read_b64_tr_b16 v[148:149], v12 offset:0
    ds_read_b64_tr_b16 v[150:151], v12 offset:512
    v_mov_b32 v28, v16
    v_mov_b32 v29, v16
    v_mov_b32 v30, v16
    v_mfma_f32_32x32x16_bf16 v[96:111], v[180:183], v[176:179], v[96:111]
    v_mov_b32 v31, v16
    v_mov_b32 v64, 0
    v_mov_b32 v65, 0
    v_mov_b32 v66, 0
    v_mov_b32 v67, 0
    s_add_u32 m0, s46, 131072
    s_add_u32 s56, s54, 5
    s_cmp_ge_u32 s56, 7
    s_cselect_b32 s57, 6, -1
    s_sub_u32 s56, s56, s57
    s_add_u32 s56, s56, s48
    s_and_b32 s56, s56, 7
    s_lshl_b32 s57, s56, 7
    s_add_u32 s57, s57, s44
    buffer_load_dwordx4 v94, s[32:35], s57 offen  lds
    s_add_u32 m0, s46, 135168
    s_add_u32 s57, s57, 0x8000
    buffer_load_dwordx4 v94, s[32:35], s57 offen  lds
    v_mfma_f32_32x32x16_bf16 v[112:127], v[200:203], v[192:195], v[112:127]
    ds_read_b128 v[160:163], v5 offset:0
    ds_read_b64_tr_b16 v[168:169], v12 offset:10240
    ds_read_b64_tr_b16 v[170:171], v12 offset:10752
    ds_read_b64_tr_b16 v[172:173], v12 offset:18432
    v_mov_b32 v68, 0
    v_mov_b32 v69, 0
    v_mov_b32 v70, 0
    v_mfma_f32_32x32x16_bf16 v[128:143], v[192:195], v[204:207], v[128:143]
    ds_read_b64_tr_b16 v[174:175], v12 offset:18944
    ds_read_b64_tr_b16 v[164:165], v12 offset:2048
    ds_read_b64_tr_b16 v[166:167], v12 offset:2560
    v_mov_b32 v71, 0
    v_mov_b32 v72, 0
    v_mov_b32 v73, 0
    v_mfma_f32_32x32x16_bf16 v[96:111], v[196:199], v[192:195], v[96:111]
    v_mov_b32 v74, 0
    v_mov_b32 v75, 0
    v_mov_b32 v76, 0
    v_mov_b32 v77, 0
    v_mov_b32 v78, 0
    s_add_u32 m0, s47, 139264
    s_mul_i32 s56, s56, 196608
    s_add_u32 s56, s56, s45
    buffer_load_dwordx4 v95, s[36:39], s56 offen offset:0  lds
    s_add_u32 m0, s47, 146432
    s_nop 0
    buffer_load_dwordx4 v95, s[36:39], s56 offen offset:1024  lds
    s_waitcnt lgkmcnt(7)
    v_mfma_f32_32x32x16_bf16 v[112:127], v[152:155], v[144:147], v[112:127]
    ds_read_b128 v[176:179], v6 offset:0
    ds_read_b64_tr_b16 v[184:185], v12 offset:12288
    ds_read_b64_tr_b16 v[186:187], v12 offset:12800
    ds_read_b64_tr_b16 v[188:189], v12 offset:20480
    v_mov_b32 v79, 0
    v_lshlrev_b32 v1, 4, v0
    v_lshrrev_b32 v2, 5, v0
    v_mfma_f32_32x32x16_bf16 v[128:143], v[144:147], v[156:159], v[128:143]
    ds_read_b64_tr_b16 v[190:191], v12 offset:20992
    ds_read_b64_tr_b16 v[180:181], v12 offset:4096
    ds_read_b64_tr_b16 v[182:183], v12 offset:4608
    v_lshlrev_b32 v2, 8, v2
    v_and_b32 v3, 15, v0
    v_lshl_add_u32 v2, v3, 4, v2
    v_mfma_f32_32x32x16_bf16 v[96:111], v[148:151], v[144:147], v[96:111]
    v_add_u32 v2, 1024, v2
    v_add_u32 v80, 0x10000, v1
    v_add_u32 v81, 0x10000, v2
    v_mov_b32 v3, 0xdddddddd
    s_add_u32 m0, s47, 153600
    s_nop 0
    buffer_load_dwordx4 v95, s[36:39], s56 offen offset:2048  lds
    s_add_u32 m0, s47, 140288
    s_add_u32 s56, s56, 24576
    buffer_load_dwordx4 v95, s[36:39], s56 offen offset:0  lds
    s_waitcnt lgkmcnt(7)
    v_mfma_f32_32x32x16_bf16 v[112:127], v[168:171], v[160:163], v[112:127]
    ds_read_b128 v[192:195], v7 offset:0
    ds_read_b64_tr_b16 v[200:201], v12 offset:14336
    ds_read_b64_tr_b16 v[202:203], v12 offset:14848
    ds_read_b64_tr_b16 v[204:205], v12 offset:22528
    v_mfma_f32_32x32x16_bf16 v[128:143], v[160:163], v[172:175], v[128:143]
    ds_read_b64_tr_b16 v[206:207], v12 offset:23040
    ds_read_b64_tr_b16 v[196:197], v12 offset:6144
    ds_read_b64_tr_b16 v[198:199], v12 offset:6656
    v_mfma_f32_32x32x16_bf16 v[96:111], v[164:167], v[160:163], v[96:111]
    s_add_u32 m0, s47, 147456
    s_nop 0
    buffer_load_dwordx4 v95, s[36:39], s56 offen offset:1024  lds
    s_add_u32 m0, s47, 154624
    s_nop 0
    buffer_load_dwordx4 v95, s[36:39], s56 offen offset:2048  lds
    s_waitcnt lgkmcnt(0)
    s_waitcnt vmcnt(16)
    s_barrier
    v_mfma_f32_32x32x16_bf16 v[112:127], v[184:187], v[176:179], v[112:127]
    ds_read_b128 v[144:147], v4 offset:32768
    ds_read_b64_tr_b16 v[152:153], v12 offset:40960
    ds_read_b64_tr_b16 v[154:155], v12 offset:41472
    ds_read_b64_tr_b16 v[156:157], v12 offset:49152
    v_mfma_f32_32x32x16_bf16 v[128:143], v[176:179], v[188:191], v[128:143]
    ds_read_b64_tr_b16 v[158:159], v12 offset:49664
    ds_read_b64_tr_b16 v[148:149], v12 offset:32768
    ds_read_b64_tr_b16 v[150:151], v12 offset:33280
    v_mfma_f32_32x32x16_bf16 v[96:111], v[180:183], v[176:179], v[96:111]
    s_add_u32 m0, s46, 32768
    s_add_u32 s56, s54, 6
    s_cmp_ge_u32 s56, 7
    s_cselect_b32 s57, 6, -1
    s_sub_u32 s56, s56, s57
    s_add_u32 s56, s56, s48
    s_and_b32 s56, s56, 7
    s_lshl_b32 s57, s56, 7
    s_add_u32 s57, s57, s44
    buffer_load_dwordx4 v94, s[32:35], s57 offen  lds
    s_add_u32 m0, s46, 36864
    s_add_u32 s57, s57, 0x8000
    buffer_load_dwordx4 v94, s[32:35], s57 offen  lds
    v_mfma_f32_32x32x16_bf16 v[112:127], v[200:203], v[192:195], v[112:127]
    ds_read_b128 v[160:163], v5 offset:32768
    ds_read_b64_tr_b16 v[168:169], v12 offset:43008
    ds_read_b64_tr_b16 v[170:171], v12 offset:43520
    ds_read_b64_tr_b16 v[172:173], v12 offset:51200
    v_mfma_f32_32x32x16_bf16 v[128:143], v[192:195], v[204:207], v[128:143]
    ds_read_b64_tr_b16 v[174:175], v12 offset:51712
    ds_read_b64_tr_b16 v[164:165], v12 offset:34816
    ds_read_b64_tr_b16 v[166:167], v12 offset:35328
    v_mfma_f32_32x32x16_bf16 v[96:111], v[196:199], v[192:195], v[96:111]
    s_add_u32 m0, s47, 40960
    s_mul_i32 s56, s56, 196608
    s_add_u32 s56, s56, s45
    buffer_load_dwordx4 v95, s[36:39], s56 offen offset:0  lds
    s_add_u32 m0, s47, 48128
    s_nop 0
    buffer_load_dwordx4 v95, s[36:39], s56 offen offset:1024  lds
    s_waitcnt lgkmcnt(7)
    v_mfma_f32_32x32x16_bf16 v[112:127], v[152:155], v[144:147], v[112:127]
    ds_read_b128 v[176:179], v6 offset:32768
    ds_read_b64_tr_b16 v[184:185], v12 offset:45056
    ds_read_b64_tr_b16 v[186:187], v12 offset:45568
    ds_read_b64_tr_b16 v[188:189], v12 offset:53248
    v_mfma_f32_32x32x16_bf16 v[128:143], v[144:147], v[156:159], v[128:143]
    ds_read_b64_tr_b16 v[190:191], v12 offset:53760
    ds_read_b64_tr_b16 v[180:181], v12 offset:36864
    ds_read_b64_tr_b16 v[182:183], v12 offset:37376
    v_mfma_f32_32x32x16_bf16 v[96:111], v[148:151], v[144:147], v[96:111]
    s_add_u32 m0, s47, 55296
    s_nop 0
    buffer_load_dwordx4 v95, s[36:39], s56 offen offset:2048  lds
    s_add_u32 m0, s47, 41984
    s_add_u32 s56, s56, 24576
    buffer_load_dwordx4 v95, s[36:39], s56 offen offset:0  lds
    s_waitcnt lgkmcnt(7)
    v_mfma_f32_32x32x16_bf16 v[112:127], v[168:171], v[160:163], v[112:127]
    ds_read_b128 v[192:195], v7 offset:32768
    ds_read_b64_tr_b16 v[200:201], v12 offset:47104
    ds_read_b64_tr_b16 v[202:203], v12 offset:47616
    ds_read_b64_tr_b16 v[204:205], v12 offset:55296
    v_mfma_f32_32x32x16_bf16 v[128:143], v[160:163], v[172:175], v[128:143]
    ds_read_b64_tr_b16 v[206:207], v12 offset:55808
    ds_read_b64_tr_b16 v[196:197], v12 offset:38912
    ds_read_b64_tr_b16 v[198:199], v12 offset:39424
    v_mfma_f32_32x32x16_bf16 v[96:111], v[164:167], v[160:163], v[96:111]
    s_add_u32 m0, s47, 49152
    s_nop 0
    buffer_load_dwordx4 v95, s[36:39], s56 offen offset:1024  lds
    s_add_u32 m0, s47, 56320
    s_nop 0
    buffer_load_dwordx4 v95, s[36:39], s56 offen offset:2048  lds
    s_waitcnt lgkmcnt(0)
    s_waitcnt vmcnt(16)
    s_barrier
    v_mfma_f32_32x32x16_bf16 v[112:127], v[184:187], v[176:179], v[112:127]
    ds_read_b128 v[144:147], v8 offset:0
    ds_read_b64_tr_b16 v[152:153], v13 offset:8192
    ds_read_b64_tr_b16 v[154:155], v13 offset:8704
    ds_read_b64_tr_b16 v[156:157], v13 offset:16384
    v_mfma_f32_32x32x16_bf16 v[128:143], v[176:179], v[188:191], v[128:143]
    ds_read_b64_tr_b16 v[158:159], v13 offset:16896
    ds_read_b64_tr_b16 v[148:149], v13 offset:0
    ds_read_b64_tr_b16 v[150:151], v13 offset:512
    v_mfma_f32_32x32x16_bf16 v[96:111], v[180:183], v[176:179], v[96:111]
    buffer_load_dwordx2 v[244:245], v53, s[40:43], s72 offen sc1
    v_mfma_f32_32x32x16_bf16 v[112:127], v[200:203], v[192:195], v[112:127]
    ds_read_b128 v[160:163], v9 offset:0
    ds_read_b64_tr_b16 v[168:169], v13 offset:10240
    ds_read_b64_tr_b16 v[170:171], v13 offset:10752
    ds_read_b64_tr_b16 v[172:173], v13 offset:18432
    v_mfma_f32_32x32x16_bf16 v[128:143], v[192:195], v[204:207], v[128:143]
    ds_read_b64_tr_b16 v[174:175], v13 offset:18944
    ds_read_b64_tr_b16 v[164:165], v13 offset:2048
    ds_read_b64_tr_b16 v[166:167], v13 offset:2560
    v_mfma_f32_32x32x16_bf16 v[96:111], v[196:199], v[192:195], v[96:111]
    s_waitcnt lgkmcnt(7)
    v_mfma_f32_32x32x16_bf16 v[112:127], v[152:155], v[144:147], v[112:127]
    ds_read_b128 v[176:179], v10 offset:0
    ds_read_b64_tr_b16 v[184:185], v13 offset:12288
    ds_read_b64_tr_b16 v[186:187], v13 offset:12800
    ds_read_b64_tr_b16 v[188:189], v13 offset:20480
    v_mfma_f32_32x32x16_bf16 v[128:143], v[144:147], v[156:159], v[128:143]
    ds_read_b64_tr_b16 v[190:191], v13 offset:20992
    ds_read_b64_tr_b16 v[180:181], v13 offset:4096
    ds_read_b64_tr_b16 v[182:183], v13 offset:4608
    v_mfma_f32_32x32x16_bf16 v[96:111], v[148:151], v[144:147], v[96:111]
    s_waitcnt lgkmcnt(7)
    v_mfma_f32_32x32x16_bf16 v[112:127], v[168:171], v[160:163], v[112:127]
    ds_read_b128 v[192:195], v11 offset:0
    ds_read_b64_tr_b16 v[200:201], v13 offset:14336
    ds_read_b64_tr_b16 v[202:203], v13 offset:14848
    ds_read_b64_tr_b16 v[204:205], v13 offset:22528
    v_mfma_f32_32x32x16_bf16 v[128:143], v[160:163], v[172:175], v[128:143]
    ds_read_b64_tr_b16 v[206:207], v13 offset:23040
    ds_read_b64_tr_b16 v[196:197], v13 offset:6144
    ds_read_b64_tr_b16 v[198:199], v13 offset:6656
    v_mfma_f32_32x32x16_bf16 v[96:111], v[164:167], v[160:163], v[96:111]
    s_waitcnt lgkmcnt(0)
    s_waitcnt vmcnt(9)
    s_barrier
    v_mfma_f32_32x32x16_bf16 v[112:127], v[184:187], v[176:179], v[112:127]
    ds_read_b128 v[144:147], v8 offset:32768
    ds_read_b64_tr_b16 v[152:153], v13 offset:40960
    ds_read_b64_tr_b16 v[154:155], v13 offset:41472
    ds_read_b64_tr_b16 v[156:157], v13 offset:49152
    v_mfma_f32_32x32x16_bf16 v[128:143], v[176:179], v[188:191], v[128:143]
    ds_read_b64_tr_b16 v[158:159], v13 offset:49664
    ds_read_b64_tr_b16 v[148:149], v13 offset:32768
    ds_read_b64_tr_b16 v[150:151], v13 offset:33280
    v_mfma_f32_32x32x16_bf16 v[96:111], v[180:183], v[176:179], v[96:111]
    global_load_short_d16 v44, v52, s[8:9] offset:0
    global_load_short_d16_hi v45, v52, s[8:9] offset:1024
    global_load_short_d16 v46, v52, s[8:9] offset:2048
    v_mfma_f32_32x32x16_bf16 v[112:127], v[200:203], v[192:195], v[112:127]
    ds_read_b128 v[160:163], v9 offset:32768
    ds_read_b64_tr_b16 v[168:169], v13 offset:43008
    ds_read_b64_tr_b16 v[170:171], v13 offset:43520
    ds_read_b64_tr_b16 v[172:173], v13 offset:51200
    v_mfma_f32_32x32x16_bf16 v[128:143], v[192:195], v[204:207], v[128:143]
    ds_read_b64_tr_b16 v[174:175], v13 offset:51712
    ds_read_b64_tr_b16 v[164:165], v13 offset:34816
    ds_read_b64_tr_b16 v[166:167], v13 offset:35328
    v_mfma_f32_32x32x16_bf16 v[96:111], v[196:199], v[192:195], v[96:111]
    global_load_short_d16_hi v47, v52, s[8:9] offset:3072
    global_load_short_d16 v48, v57, s[8:9] offset:0
    global_load_short_d16_hi v49, v57, s[8:9] offset:1024
    s_waitcnt lgkmcnt(7)
    v_mfma_f32_32x32x16_bf16 v[112:127], v[152:155], v[144:147], v[112:127]
    ds_read_b128 v[176:179], v10 offset:32768
    ds_read_b64_tr_b16 v[184:185], v13 offset:45056
    ds_read_b64_tr_b16 v[186:187], v13 offset:45568
    ds_read_b64_tr_b16 v[188:189], v13 offset:53248
    v_mfma_f32_32x32x16_bf16 v[128:143], v[144:147], v[156:159], v[128:143]
    ds_read_b64_tr_b16 v[190:191], v13 offset:53760
    ds_read_b64_tr_b16 v[180:181], v13 offset:36864
    ds_read_b64_tr_b16 v[182:183], v13 offset:37376
    v_mfma_f32_32x32x16_bf16 v[96:111], v[148:151], v[144:147], v[96:111]
    global_load_short_d16 v50, v57, s[8:9] offset:2048
    global_load_short_d16_hi v51, v57, s[8:9] offset:3072
    global_load_dwordx4 v[32:35], v14, s[4:5]
    s_waitcnt lgkmcnt(7)
    v_mfma_f32_32x32x16_bf16 v[112:127], v[168:171], v[160:163], v[112:127]
    ds_read_b128 v[192:195], v11 offset:32768
    ds_read_b64_tr_b16 v[200:201], v13 offset:47104
    ds_read_b64_tr_b16 v[202:203], v13 offset:47616
    ds_read_b64_tr_b16 v[204:205], v13 offset:55296
    v_mfma_f32_32x32x16_bf16 v[128:143], v[160:163], v[172:175], v[128:143]
    ds_read_b64_tr_b16 v[206:207], v13 offset:55808
    ds_read_b64_tr_b16 v[196:197], v13 offset:38912
    ds_read_b64_tr_b16 v[198:199], v13 offset:39424
    v_mfma_f32_32x32x16_bf16 v[96:111], v[164:167], v[160:163], v[96:111]
    global_load_dwordx4 v[36:39], v14, s[4:5] offset:1024
    global_load_dwordx4 v[40:43], v15, s[24:25]
    s_waitcnt lgkmcnt(0)
    s_waitcnt vmcnt(12)
    s_barrier
    v_mfma_f32_32x32x16_bf16 v[112:127], v[184:187], v[176:179], v[112:127]
    ds_read_b128 v[144:147], v4 offset:0
    ds_read_b64_tr_b16 v[152:153], v12 offset:8192
    ds_read_b64_tr_b16 v[154:155], v12 offset:8704
    ds_read_b64_tr_b16 v[156:157], v12 offset:16384
    v_mfma_f32_32x32x16_bf16 v[128:143], v[176:179], v[188:191], v[128:143]
    ds_read_b64_tr_b16 v[158:159], v12 offset:16896
    ds_read_b64_tr_b16 v[148:149], v12 offset:0
    ds_read_b64_tr_b16 v[150:151], v12 offset:512
    v_mfma_f32_32x32x16_bf16 v[96:111], v[180:183], v[176:179], v[96:111]
    v_mfma_f32_32x32x16_bf16 v[112:127], v[200:203], v[192:195], v[112:127]
    ds_read_b128 v[160:163], v5 offset:0
    ds_read_b64_tr_b16 v[168:169], v12 offset:10240
    ds_read_b64_tr_b16 v[170:171], v12 offset:10752
    ds_read_b64_tr_b16 v[172:173], v12 offset:18432
    v_mfma_f32_32x32x16_bf16 v[128:143], v[192:195], v[204:207], v[128:143]
    ds_read_b64_tr_b16 v[174:175], v12 offset:18944
    ds_read_b64_tr_b16 v[164:165], v12 offset:2048
    ds_read_b64_tr_b16 v[166:167], v12 offset:2560
    v_mfma_f32_32x32x16_bf16 v[96:111], v[196:199], v[192:195], v[96:111]
    s_waitcnt lgkmcnt(7)
    v_mfma_f32_32x32x16_bf16 v[112:127], v[152:155], v[144:147], v[112:127]
    ds_read_b128 v[176:179], v6 offset:0
    ds_read_b64_tr_b16 v[184:185], v12 offset:12288
    ds_read_b64_tr_b16 v[186:187], v12 offset:12800
    ds_read_b64_tr_b16 v[188:189], v12 offset:20480
    v_mfma_f32_32x32x16_bf16 v[128:143], v[144:147], v[156:159], v[128:143]
    ds_read_b64_tr_b16 v[190:191], v12 offset:20992
    ds_read_b64_tr_b16 v[180:181], v12 offset:4096
    ds_read_b64_tr_b16 v[182:183], v12 offset:4608
    v_mfma_f32_32x32x16_bf16 v[96:111], v[148:151], v[144:147], v[96:111]
    s_waitcnt lgkmcnt(7)
    v_mfma_f32_32x32x16_bf16 v[112:127], v[168:171], v[160:163], v[112:127]
    ds_read_b128 v[192:195], v7 offset:0
    ds_read_b64_tr_b16 v[200:201], v12 offset:14336
    ds_read_b64_tr_b16 v[202:203], v12 offset:14848
    ds_read_b64_tr_b16 v[204:205], v12 offset:22528
    v_mfma_f32_32x32x16_bf16 v[128:143], v[160:163], v[172:175], v[128:143]
    ds_read_b64_tr_b16 v[206:207], v12 offset:23040
    ds_read_b64_tr_b16 v[196:197], v12 offset:6144
    ds_read_b64_tr_b16 v[198:199], v12 offset:6656
    v_mfma_f32_32x32x16_bf16 v[96:111], v[164:167], v[160:163], v[96:111]
    s_waitcnt lgkmcnt(0)
    v_mfma_f32_32x32x16_bf16 v[112:127], v[184:187], v[176:179], v[112:127]
    v_mfma_f32_32x32x16_bf16 v[112:127], v[200:203], v[192:195], v[112:127]
    v_mfma_f32_32x32x16_bf16 v[128:143], v[176:179], v[188:191], v[128:143]
    v_mfma_f32_32x32x16_bf16 v[128:143], v[192:195], v[204:207], v[128:143]
    v_mfma_f32_32x32x16_bf16 v[96:111], v[180:183], v[176:179], v[96:111]
    s_nop 6
    s_nop 1
    v_cvt_pk_bf16_f32 v144, v112, v113
    v_cvt_pk_bf16_f32 v145, v114, v115
    v_cvt_pk_bf16_f32 v146, v116, v117
    v_cvt_pk_bf16_f32 v147, v118, v119
    v_mfma_f32_32x32x16_bf16 v[96:111], v[196:199], v[192:195], v[96:111]
    v_cvt_pk_bf16_f32 v148, v120, v121
    v_cvt_pk_bf16_f32 v149, v122, v123
    v_cvt_pk_bf16_f32 v150, v124, v125
    v_cvt_pk_bf16_f32 v151, v126, v127
    buffer_store_dwordx4 v[144:147], v55, s[40:43], s63 offen sc1
    buffer_store_dwordx4 v[148:151], v55, s[40:43], s64 offen sc1
    v_cvt_pk_bf16_f32 v152, v128, v129
    v_cvt_pk_bf16_f32 v153, v130, v131
    v_cvt_pk_bf16_f32 v154, v132, v133
    v_cvt_pk_bf16_f32 v155, v134, v135
    v_cvt_pk_bf16_f32 v156, v136, v137
    v_cvt_pk_bf16_f32 v157, v138, v139
    v_cvt_pk_bf16_f32 v158, v140, v141
    v_cvt_pk_bf16_f32 v159, v142, v143
    buffer_store_dwordx4 v[152:155], v56, s[40:43], s63 offen offset:1024 sc1
    buffer_store_dwordx4 v[156:159], v56, s[40:43], s63 offen offset:1536 sc1
    s_waitcnt vmcnt(15)
    s_mov_b32 s92, 400000
    s_branch L_s1g_chk
L_s1g_poll:
    buffer_load_dwordx2 v[244:245], v53, s[40:43], s72 offen sc1
    s_waitcnt vmcnt(0)
L_s1g_chk:
    v_cmp_ne_u32 vcc, v244, v240
    s_nop 1
    s_cbranch_vccz L_s1g_ok
    s_sleep 4
    s_sub_u32 s92, s92, 1
    s_cmp_lg_u32 s92, 0
    s_cbranch_scc1 L_s1g_poll
L_s1g_ok:
    v_cmp_ne_u32 s[72:73], v245, v241
    v_mul_f32 v96, s65, v96
    v_mul_f32 v97, s65, v97
    v_mul_f32 v98, s65, v98
    v_mul_f32 v99, s65, v99
    v_mul_f32 v100, s65, v100
    v_mul_f32 v101, s65, v101
    v_mul_f32 v102, s65, v102
    v_mul_f32 v103, s65, v103
    v_cvt_pk_bf16_f32 v160, v96, v97
    v_cvt_pk_bf16_f32 v161, v98, v99
    v_cvt_pk_bf16_f32 v162, v100, v101
    v_cvt_pk_bf16_f32 v163, v102, v103
    v_mul_f32 v104, s65, v104
    v_mul_f32 v105, s65, v105
    v_mul_f32 v106, s65, v106
    v_mul_f32 v107, s65, v107
    v_mul_f32 v108, s65, v108
    v_mul_f32 v109, s65, v109
    v_mul_f32 v110, s65, v110
    v_mul_f32 v111, s65, v111
    v_cvt_pk_bf16_f32 v164, v104, v105
    v_cvt_pk_bf16_f32 v165, v106, v107
    v_cvt_pk_bf16_f32 v166, v108, v109
    v_cvt_pk_bf16_f32 v167, v110, v111
    s_cmp_eq_u64 s[72:73], 0
    s_cbranch_scc0 L_q_far
    buffer_store_dwordx4 v[160:163], v1, s[40:43], s61 offen
    buffer_store_dwordx4 v[164:167], v1, s[40:43], s62 offen
    s_branch L_q_done
L_q_far:
    buffer_store_dwordx4 v[160:163], v1, s[40:43], s61 offen sc1
    buffer_store_dwordx4 v[164:167], v1, s[40:43], s62 offen sc1
L_q_done:
    s_mov_b32 s68, 0xffff0000
    s_waitcnt vmcnt(6)
    v_lshlrev_b32 v168, 16, v40
    v_and_b32 v169, s68, v40
    v_lshlrev_b32 v170, 16, v41
    v_and_b32 v171, s68, v41
    v_lshlrev_b32 v172, 16, v42
    v_and_b32 v173, s68, v42
    v_lshlrev_b32 v174, 16, v43
    v_and_b32 v175, s68, v43
    v_lshlrev_b32 v180, 16, v32
    v_and_b32 v181, s68, v32
    v_mul_f32 v180, v180, v168
    v_mul_f32 v181, v181, v169
    v_cvt_pk_bf16_f32 v32, v180, v181
    v_lshlrev_b32 v182, 16, v36
    v_and_b32 v183, s68, v36
    v_mul_f32 v182, v182, v168
    v_mul_f32 v183, v183, v169
    v_cvt_pk_bf16_f32 v36, v182, v183
    v_lshlrev_b32 v180, 16, v33
    v_and_b32 v181, s68, v33
    v_mul_f32 v180, v180, v170
    v_mul_f32 v181, v181, v171
    v_cvt_pk_bf16_f32 v33, v180, v181
    v_lshlrev_b32 v182, 16, v37
    v_and_b32 v183, s68, v37
    v_mul_f32 v182, v182, v170
    v_mul_f32 v183, v183, v171
    v_cvt_pk_bf16_f32 v37, v182, v183
    v_lshlrev_b32 v180, 16, v34
    v_and_b32 v181, s68, v34
    v_mul_f32 v180, v180, v172
    v_mul_f32 v181, v181, v173
    v_cvt_pk_bf16_f32 v34, v180, v181
    v_lshlrev_b32 v182, 16, v38
    v_and_b32 v183, s68, v38
    v_mul_f32 v182, v182, v172
    v_mul_f32 v183, v183, v173
    v_cvt_pk_bf16_f32 v38, v182, v183
    v_lshlrev_b32 v180, 16, v35
    v_and_b32 v181, s68, v35
    v_mul_f32 v180, v180, v174
    v_mul_f32 v181, v181, v175
    v_cvt_pk_bf16_f32 v35, v180, v181
    v_lshlrev_b32 v182, 16, v39
    v_and_b32 v183, s68, v39
    v_mul_f32 v182, v182, v174
    v_mul_f32 v183, v183, v175
    v_cvt_pk_bf16_f32 v39, v182, v183
    s_waitcnt vmcnt(0)
    s_cmp_eq_u64 s[72:73], 0
    s_cbranch_scc0 L_st_far
    s_mov_b64 exec, 1
    buffer_store_dword v240, v242, s[40:43], s70 offen
    s_mov_b64 exec, -1
    s_branch L_st_done
L_st_far:
    s_mov_b64 exec, 1
    buffer_store_dword v240, v242, s[40:43], s70 offen sc1
    s_mov_b64 exec, -1
L_st_done:
    buffer_load_dword v244, v54, s[40:43], s71 offen sc1
    v_and_b32 v181, s68, v32
    v_lshlrev_b32 v180, 16, v32
    v_add_f32 v176, v180, v181
    v_and_b32 v183, s68, v36
    v_lshlrev_b32 v182, 16, v36
    v_add_f32 v177, v182, v183
    v_and_b32 v181, s68, v33
    v_lshlrev_b32 v180, 16, v33
    v_add_f32 v176, v176, v180
    v_add_f32 v176, v176, v181
    v_and_b32 v183, s68, v37
    v_lshlrev_b32 v182, 16, v37
    v_add_f32 v177, v177, v182
    v_add_f32 v177, v177, v183
    v_and_b32 v181, s68, v34
    v_lshlrev_b32 v180, 16, v34
    v_add_f32 v176, v176, v180
    v_add_f32 v176, v176, v181
    v_and_b32 v183, s68, v38
    v_lshlrev_b32 v182, 16, v38
    v_add_f32 v177, v177, v182
    v_add_f32 v177, v177, v183
    v_and_b32 v181, s68, v35
    v_lshlrev_b32 v180, 16, v35
    v_add_f32 v176, v176, v180
    v_add_f32 v176, v176, v181
    v_and_b32 v183, s68, v39
    v_lshlrev_b32 v182, 16, v39
    v_add_f32 v177, v177, v182
    v_add_f32 v177, v177, v183
    v_or_b32 v227, v50, v51
    v_add_f32_dpp v176, v176, v176 row_shr:1 row_mask:0xf bank_mask:0xf bound_ctrl:0
    v_add_f32_dpp v177, v177, v177 row_shr:1 row_mask:0xf bank_mask:0xf bound_ctrl:0
    v_or_b32 v226, v48, v49
    v_add_f32_dpp v176, v176, v176 row_shr:2 row_mask:0xf bank_mask:0xf bound_ctrl:0
    v_add_f32_dpp v177, v177, v177 row_shr:2 row_mask:0xf bank_mask:0xf bound_ctrl:0
    v_or_b32 v225, v46, v47
    v_add_f32_dpp v176, v176, v176 row_shr:4 row_mask:0xf bank_mask:0xf bound_ctrl:0
    v_add_f32_dpp v177, v177, v177 row_shr:4 row_mask:0xf bank_mask:0xf bound_ctrl:0
    v_or_b32 v224, v44, v45
    v_add_f32_dpp v176, v176, v176 row_shr:8 row_mask:0xf bank_mask:0xf bound_ctrl:0
    v_add_f32_dpp v177, v177, v177 row_shr:8 row_mask:0xf bank_mask:0xf bound_ctrl:0
    s_nop 0
    v_add_f32_dpp v176, v176, v176 row_bcast:15 row_mask:0xa bank_mask:0xf
    v_add_f32_dpp v177, v177, v177 row_bcast:15 row_mask:0xa bank_mask:0xf
    s_nop 0
    v_add_f32_dpp v176, v176, v176 row_bcast:31 row_mask:0xc bank_mask:0xf
    v_add_f32_dpp v177, v177, v177 row_bcast:31 row_mask:0xc bank_mask:0xf
    v_cvt_pk_bf16_f32 v178, v176, v177
    s_mov_b32 s60, 1069066811
    v_lshlrev_b32 v176, 16, v178
    v_and_b32 v177, s68, v178
    v_mul_f32 v176, s60, v176
    v_mul_f32 v177, s60, v177
    v_exp_f32 v176, -v176
    v_exp_f32 v177, -v177
    v_add_f32 v176, 1.0, v176
    v_add_f32 v177, 1.0, v177
    v_rcp_f32 v176, v176
    v_rcp_f32 v177, v177
    s_nop 0
    v_cvt_pk_bf16_f32 v178, v176, v177
    v_lshlrev_b32 v228, 16, v178
    v_and_b32 v229, s68, v178
    s_waitcnt vmcnt(0)
    s_mov_b32 s92, 400000
    s_branch L_s2_chk
L_s2_poll:
    buffer_load_dword v244, v54, s[40:43], s71 offen sc1
    s_waitcnt vmcnt(0)
L_s2_chk:
    v_cmp_ne_u32 vcc, v244, v240
    s_nop 1
    s_cbranch_vccz L_s2_ok
    s_sleep 1
    s_sub_u32 s92, s92, 1
    s_cmp_lg_u32 s92, 0
    s_cbranch_scc1 L_s2_poll
L_s2_ok:
    buffer_load_dwordx4 v[4:7], v1, s[40:43], s77 offen sc1
    s_add_u32 m0, s79, 147456
    s_add_u32 s80, s77, 4096
    buffer_load_dwordx4 v1, s[40:43], s80 offen sc1 lds
    s_add_u32 m0, s79, 98304
    s_add_u32 s80, s78, 98304
    buffer_load_dwordx4 v1, s[40:43], s80 offen sc1 lds
    s_add_u32 m0, s79, 102400
    s_add_u32 s80, s78, 102400
    buffer_load_dwordx4 v1, s[40:43], s80 offen sc1 lds
    s_add_u32 m0, s79, 106496
    s_add_u32 s80, s78, 106496
    buffer_load_dwordx4 v1, s[40:43], s80 offen sc1 lds
    s_add_u32 m0, s79, 110592
    s_add_u32 s80, s78, 110592
    buffer_load_dwordx4 v1, s[40:43], s80 offen sc1 lds
    s_add_u32 m0, s79, 114688
    s_add_u32 s80, s78, 114688
    buffer_load_dwordx4 v1, s[40:43], s80 offen sc1 lds
    s_add_u32 m0, s79, 118784
    s_add_u32 s80, s78, 118784
    buffer_load_dwordx4 v1, s[40:43], s80 offen sc1 lds
    s_waitcnt vmcnt(0)
    s_branch L_att
L_aux:
    s_setprio 2
    s_mul_i32 s65, s51, 8704
    s_mov_b32 m0, s65
    s_mov_b32 s66, 1069066811
    s_mov_b32 s68, 0xffff0000
    s_mov_b32 s69, 1042479491
    s_mov_b32 s62, 0x41000000
    s_mov_b32 s63, 0x43800000
    v_and_b32 v1, 31, v0
    v_lshrrev_b32 v2, 5, v0
    v_lshlrev_b32 v2, 4, v2
    s_mul_i32 s73, s52, 17408
    v_add_u32 v54, s73, v2
    v_mov_b32 v3, 272
    v_mad_u32_u24 v7, v1, v3, v54
    s_mul_i32 s65, s51, 7344
    s_mul_i32 s73, s52, 14688
    v_add_u32 v2, s73, v2
    v_bfe_u32 v8, v0, 3, 1
    v_and_b32 v9, 3, v0
    v_lshl_add_u32 v8, v8, 2, v9
    v_cvt_f32_u32 v8, v8
    v_bfe_u32 v9, v0, 4, 1
    v_bfe_u32 v52, v0, 2, 1
    v_lshl_add_u32 v9, v9, 1, v52
    v_min_u32 v52, 2, v9
    v_sub_u32 v52, 0, v52
    v_ldexp_f32 v52, v8, v52
    v_rndne_f32 v52, v52
    v_cvt_u32_f32 v52, v52
    v_lshlrev_b32 v53, 3, v9
    s_mov_b32 s73, 0x100d0800
    v_lshrrev_b32 v53, v53, s73
    s_waitcnt vmcnt(0)
    v_mul_f32 v14, s66, v14
    v_mul_f32 v10, s66, v10
    v_exp_f32 v14, v14
    v_exp_f32 v10, v10
    s_mov_b32 s56, 1664525
    v_mul_lo_u32 v240, v240, s56
    v_add_u32 v240, 1013904223, v240
    v_cvt_pk_bf16_f32 v15, v14, v10
    v_lshlrev_b32 v14, 16, v15
    v_and_b32 v10, s68, v15
    v_mul_f32 v10, v10, v14
    v_mul_f32 v11, v11, v14
    v_mul_f32 v10, s66, v10
    v_mul_f32 v11, s69, v11
    v_mul_f32 v32, s62, v10
    v_mul_f32 v33, s62, v11
    v_exp_f32 v32, -v32
    v_fract_f32 v33, v33
    v_cos_f32 v78, v33
    v_sin_f32 v79, v33
    v_mul_f32 v78, v32, v78
    v_mul_f32 v79, v32, v79
    v_pk_mul_f32 v[56:57], v[78:79], v[78:79] op_sel:[0,0] op_sel_hi:[1,0]
    v_pk_fma_f32 v[80:81], v[78:79], v[78:79], v[56:57] op_sel:[1,1,0] op_sel_hi:[0,1,1] neg_lo:[1,0,0]
    v_pk_mul_f32 v[56:57], v[80:81], v[78:79] op_sel:[0,0] op_sel_hi:[1,0]
    v_pk_mul_f32 v[58:59], v[80:81], v[80:81] op_sel:[0,0] op_sel_hi:[1,0]
    v_pk_fma_f32 v[82:83], v[80:81], v[78:79], v[56:57] op_sel:[1,1,0] op_sel_hi:[0,1,1] neg_lo:[1,0,0]
    v_pk_fma_f32 v[84:85], v[80:81], v[80:81], v[58:59] op_sel:[1,1,0] op_sel_hi:[0,1,1] neg_lo:[1,0,0]
    v_mov_b32 v72, 0x3f80
    v_cvt_pk_bf16_f32 v73, v78, v79
    v_cvt_pk_bf16_f32 v74, v80, v81
    v_cvt_pk_bf16_f32 v75, v82, v83
    ds_write_addtid_b32 v72 offset:0
    ds_write_addtid_b32 v73 offset:272
    ds_write_addtid_b32 v74 offset:544
    ds_write_addtid_b32 v75 offset:816
    v_pk_mul_f32 v[56:57], v[78:79], v[84:85] op_sel:[0,0] op_sel_hi:[1,0]
    v_pk_mul_f32 v[58:59], v[80:81], v[84:85] op_sel:[0,0] op_sel_hi:[1,0]
    v_pk_mul_f32 v[60:61], v[82:83], v[84:85] op_sel:[0,0] op_sel_hi:[1,0]
    v_pk_fma_f32 v[78:79], v[78:79], v[84:85], v[56:57] op_sel:[1,1,0] op_sel_hi:[0,1,1] neg_lo:[1,0,0]
    v_pk_fma_f32 v[80:81], v[80:81], v[84:85], v[58:59] op_sel:[1,1,0] op_sel_hi:[0,1,1] neg_lo:[1,0,0]
    v_pk_fma_f32 v[82:83], v[82:83], v[84:85], v[60:61] op_sel:[1,1,0] op_sel_hi:[0,1,1] neg_lo:[1,0,0]
    v_cvt_pk_bf16_f32 v16, v84, v85
    v_cvt_pk_bf16_f32 v17, v78, v79
    v_cvt_pk_bf16_f32 v18, v80, v81
    v_cvt_pk_bf16_f32 v19, v82, v83
    ds_write_addtid_b32 v16 offset:1088
    ds_write_addtid_b32 v17 offset:1360
    ds_write_addtid_b32 v18 offset:1632
    ds_write_addtid_b32 v19 offset:1904
    v_pk_mul_f32 v[56:57], v[84:85], v[84:85] op_sel:[0,0] op_sel_hi:[1,0]
    v_pk_mul_f32 v[58:59], v[78:79], v[84:85] op_sel:[0,0] op_sel_hi:[1,0]
    v_pk_mul_f32 v[60:61], v[80:81], v[84:85] op_sel:[0,0] op_sel_hi:[1,0]
    v_pk_mul_f32 v[62:63], v[82:83], v[84:85] op_sel:[0,0] op_sel_hi:[1,0]
    v_pk_fma_f32 v[76:77], v[84:85], v[84:85], v[56:57] op_sel:[1,1,0] op_sel_hi:[0,1,1] neg_lo:[1,0,0]
    v_pk_fma_f32 v[78:79], v[78:79], v[84:85], v[58:59] op_sel:[1,1,0] op_sel_hi:[0,1,1] neg_lo:[1,0,0]
    v_pk_fma_f32 v[80:81], v[80:81], v[84:85], v[60:61] op_sel:[1,1,0] op_sel_hi:[0,1,1] neg_lo:[1,0,0]
    v_pk_fma_f32 v[82:83], v[82:83], v[84:85], v[62:63] op_sel:[1,1,0] op_sel_hi:[0,1,1] neg_lo:[1,0,0]
    v_cvt_pk_bf16_f32 v72, v76, v77
    v_cvt_pk_bf16_f32 v73, v78, v79
    v_cvt_pk_bf16_f32 v74, v80, v81
    v_cvt_pk_bf16_f32 v75, v82, v83
    ds_write_addtid_b32 v72 offset:2176
    ds_write_addtid_b32 v73 offset:2448
    ds_write_addtid_b32 v74 offset:2720
    ds_write_addtid_b32 v75 offset:2992
    v_pk_mul_f32 v[56:57], v[76:77], v[84:85] op_sel:[0,0] op_sel_hi:[1,0]
    v_pk_mul_f32 v[58:59], v[78:79], v[84:85] op_sel:[0,0] op_sel_hi:[1,0]
    v_pk_mul_f32 v[60:61], v[80:81], v[84:85] op_sel:[0,0] op_sel_hi:[1,0]
    v_pk_mul_f32 v[62:63], v[82:83], v[84:85] op_sel:[0,0] op_sel_hi:[1,0]
    v_pk_fma_f32 v[76:77], v[76:77], v[84:85], v[56:57] op_sel:[1,1,0] op_sel_hi:[0,1,1] neg_lo:[1,0,0]
    v_pk_fma_f32 v[78:79], v[78:79], v[84:85], v[58:59] op_sel:[1,1,0] op_sel_hi:[0,1,1] neg_lo:[1,0,0]
    v_pk_fma_f32 v[80:81], v[80:81], v[84:85], v[60:61] op_sel:[1,1,0] op_sel_hi:[0,1,1] neg_lo:[1,0,0]
    v_pk_fma_f32 v[82:83], v[82:83], v[84:85], v[62:63] op_sel:[1,1,0] op_sel_hi:[0,1,1] neg_lo:[1,0,0]
    v_and_b32 v53, 0xff, v53
    v_add_u32 v52, v52, v53
    v_mul_f32 v8, 0.125, v8
    v_rndne_f32 v8, v8
    v_cvt_u32_f32 v8, v8
    v_lshl_add_u32 v8, v9, 1, v8
    v_add_u32 v8, 19, v8
    s_cmp_eq_u32 s53, 0
    s_cselect_b64 vcc, -1, 0
    s_cselect_b32 s70, 0, 0xaaaaaaaa
    s_mov_b32 s71, s70
    v_cndmask_b32 v9, v8, v52, vcc
    v_cvt_pk_bf16_f32 v16, v76, v77
    v_cvt_pk_bf16_f32 v17, v78, v79
    v_cvt_pk_bf16_f32 v18, v80, v81
    v_cvt_pk_bf16_f32 v19, v82, v83
    ds_write_addtid_b32 v16 offset:3264
    ds_write_addtid_b32 v17 offset:3536
    ds_write_addtid_b32 v18 offset:3808
    ds_write_addtid_b32 v19 offset:4080
    v_pk_mul_f32 v[56:57], v[76:77], v[84:85] op_sel:[0,0] op_sel_hi:[1,0]
    v_pk_mul_f32 v[58:59], v[78:79], v[84:85] op_sel:[0,0] op_sel_hi:[1,0]
    v_pk_mul_f32 v[60:61], v[80:81], v[84:85] op_sel:[0,0] op_sel_hi:[1,0]
    v_pk_mul_f32 v[62:63], v[82:83], v[84:85] op_sel:[0,0] op_sel_hi:[1,0]
    v_pk_fma_f32 v[76:77], v[76:77], v[84:85], v[56:57] op_sel:[1,1,0] op_sel_hi:[0,1,1] neg_lo:[1,0,0]
    v_pk_fma_f32 v[78:79], v[78:79], v[84:85], v[58:59] op_sel:[1,1,0] op_sel_hi:[0,1,1] neg_lo:[1,0,0]
    v_pk_fma_f32 v[80:81], v[80:81], v[84:85], v[60:61] op_sel:[1,1,0] op_sel_hi:[0,1,1] neg_lo:[1,0,0]
    v_pk_fma_f32 v[82:83], v[82:83], v[84:85], v[62:63] op_sel:[1,1,0] op_sel_hi:[0,1,1] neg_lo:[1,0,0]
    v_mad_u32_u24 v9, v9, v3, v2
    v_lshrrev_b32 v1, 4, v0
    v_bfe_u32 v2, v0, 2, 2
    v_lshl_add_u32 v2, v1, 3, v2
    v_bfe_u32 v3, v0, 1, 1
    s_lshl_b32 s73, s51, 1
    v_add_u32 v3, s73, v3
    v_bfe_u32 v4, v2, 1, 3
    v_xor_b32 v4, v4, v3
    v_and_b32 v5, 1, v0
    v_lshlrev_b32 v5, 3, v5
    v_lshl_add_u32 v5, v2, 7, v5
    v_cvt_pk_bf16_f32 v72, v76, v77
    v_cvt_pk_bf16_f32 v73, v78, v79
    v_cvt_pk_bf16_f32 v74, v80, v81
    v_cvt_pk_bf16_f32 v75, v82, v83
    ds_write_addtid_b32 v72 offset:4352
    ds_write_addtid_b32 v73 offset:4624
    ds_write_addtid_b32 v74 offset:4896
    ds_write_addtid_b32 v75 offset:5168
    v_pk_mul_f32 v[56:57], v[76:77], v[84:85] op_sel:[0,0] op_sel_hi:[1,0]
    v_pk_mul_f32 v[58:59], v[78:79], v[84:85] op_sel:[0,0] op_sel_hi:[1,0]
    v_pk_mul_f32 v[60:61], v[80:81], v[84:85] op_sel:[0,0] op_sel_hi:[1,0]
    v_pk_mul_f32 v[62:63], v[82:83], v[84:85] op_sel:[0,0] op_sel_hi:[1,0]
    v_pk_fma_f32 v[76:77], v[76:77], v[84:85], v[56:57] op_sel:[1,1,0] op_sel_hi:[0,1,1] neg_lo:[1,0,0]
    v_pk_fma_f32 v[78:79], v[78:79], v[84:85], v[58:59] op_sel:[1,1,0] op_sel_hi:[0,1,1] neg_lo:[1,0,0]
    v_pk_fma_f32 v[80:81], v[80:81], v[84:85], v[60:61] op_sel:[1,1,0] op_sel_hi:[0,1,1] neg_lo:[1,0,0]
    v_pk_fma_f32 v[82:83], v[82:83], v[84:85], v[62:63] op_sel:[1,1,0] op_sel_hi:[0,1,1] neg_lo:[1,0,0]
    v_add_u32 v5, 65536, v5
    v_xor_b32 v6, 2, v4
    v_lshl_add_u32 v4, v4, 4, v5
    v_lshl_add_u32 v5, v6, 4, v5
    v_bfe_u32 v6, v0, 1, 3
    v_lshlrev_b32 v6, 13, v6
    v_and_b32 v3, 1, v0
    v_lshl_add_u32 v6, v3, 6, v6
    v_lshl_add_u32 v6, v1, 4, v6
    s_lshl_b32 s60, s48, 18
    s_lshl_b32 s64, s51, 16
    s_add_u32 s60, s60, s64
    v_cvt_pk_bf16_f32 v16, v76, v77
    v_cvt_pk_bf16_f32 v17, v78, v79
    v_cvt_pk_bf16_f32 v18, v80, v81
    v_cvt_pk_bf16_f32 v19, v82, v83
    ds_write_addtid_b32 v16 offset:5440
    ds_write_addtid_b32 v17 offset:5712
    ds_write_addtid_b32 v18 offset:5984
    ds_write_addtid_b32 v19 offset:6256
    v_pk_mul_f32 v[56:57], v[76:77], v[84:85] op_sel:[0,0] op_sel_hi:[1,0]
    v_pk_mul_f32 v[58:59], v[78:79], v[84:85] op_sel:[0,0] op_sel_hi:[1,0]
    v_pk_mul_f32 v[60:61], v[80:81], v[84:85] op_sel:[0,0] op_sel_hi:[1,0]
    v_pk_mul_f32 v[62:63], v[82:83], v[84:85] op_sel:[0,0] op_sel_hi:[1,0]
    v_pk_fma_f32 v[76:77], v[76:77], v[84:85], v[56:57] op_sel:[1,1,0] op_sel_hi:[0,1,1] neg_lo:[1,0,0]
    v_pk_fma_f32 v[78:79], v[78:79], v[84:85], v[58:59] op_sel:[1,1,0] op_sel_hi:[0,1,1] neg_lo:[1,0,0]
    v_pk_fma_f32 v[80:81], v[80:81], v[84:85], v[60:61] op_sel:[1,1,0] op_sel_hi:[0,1,1] neg_lo:[1,0,0]
    v_pk_fma_f32 v[82:83], v[82:83], v[84:85], v[62:63] op_sel:[1,1,0] op_sel_hi:[0,1,1] neg_lo:[1,0,0]
    s_lshl_b32 s64, s49, 8
    s_add_u32 s60, s60, s64
    s_add_u32 s60, s60, 6291456
    s_lshl_b32 s72, s48, 2
    s_add_u32 s61, s72, s51
    s_lshl_b32 s61, s61, 8
    s_lshl_b32 s64, s49, 3
    s_add_u32 s61, s61, s64
    s_add_u32 s61, s61, 13176832
    s_lshr_b32 s64, s49, 3
    s_add_u32 s72, s72, s64
    s_lshl_b32 s72, s72, 8
    v_cvt_pk_bf16_f32 v72, v76, v77
    v_cvt_pk_bf16_f32 v73, v78, v79
    v_cvt_pk_bf16_f32 v74, v80, v81
    v_cvt_pk_bf16_f32 v75, v82, v83
    ds_write_addtid_b32 v72 offset:6528
    ds_write_addtid_b32 v73 offset:6800
    ds_write_addtid_b32 v74 offset:7072
    ds_write_addtid_b32 v75 offset:7344
    v_pk_mul_f32 v[56:57], v[76:77], v[84:85] op_sel:[0,0] op_sel_hi:[1,0]
    v_pk_mul_f32 v[58:59], v[78:79], v[84:85] op_sel:[0,0] op_sel_hi:[1,0]
    v_pk_mul_f32 v[60:61], v[80:81], v[84:85] op_sel:[0,0] op_sel_hi:[1,0]
    v_pk_mul_f32 v[62:63], v[82:83], v[84:85] op_sel:[0,0] op_sel_hi:[1,0]
    v_pk_fma_f32 v[76:77], v[76:77], v[84:85], v[56:57] op_sel:[1,1,0] op_sel_hi:[0,1,1] neg_lo:[1,0,0]
    v_pk_fma_f32 v[78:79], v[78:79], v[84:85], v[58:59] op_sel:[1,1,0] op_sel_hi:[0,1,1] neg_lo:[1,0,0]
    v_pk_fma_f32 v[80:81], v[80:81], v[84:85], v[60:61] op_sel:[1,1,0] op_sel_hi:[0,1,1] neg_lo:[1,0,0]
    v_pk_fma_f32 v[82:83], v[82:83], v[84:85], v[62:63] op_sel:[1,1,0] op_sel_hi:[0,1,1] neg_lo:[1,0,0]
    s_add_u32 s72, s72, 13176832
    s_getreg_b32 s64, hwreg(HW_REG_XCC_ID)
    v_mov_b32 v241, s64
    v_cvt_pk_bf16_f32 v16, v76, v77
    v_cvt_pk_bf16_f32 v17, v78, v79
    v_cvt_pk_bf16_f32 v18, v80, v81
    v_cvt_pk_bf16_f32 v19, v82, v83
    ds_write_addtid_b32 v16 offset:7616
    ds_write_addtid_b32 v17 offset:7888
    ds_write_addtid_b32 v18 offset:8160
    ds_write_addtid_b32 v19 offset:8432
    s_waitcnt lgkmcnt(0)
    s_barrier
    ds_read_b64_tr_b16 v[224:225], v4
    ds_read_b64_tr_b16 v[226:227], v5 offset:512
    ds_read_b64_tr_b16 v[228:229], v4 offset:4096
    ds_read_b64_tr_b16 v[230:231], v5 offset:4608
    ds_read_b128 v[96:99], v7 offset:0
    ds_read_b128 v[100:103], v7 offset:32
    ds_read_b128 v[104:107], v7 offset:64
    ds_read_b128 v[108:111], v7 offset:96
    ds_read_b128 v[112:115], v7 offset:128
    ds_read_b128 v[116:119], v7 offset:160
    ds_read_b128 v[120:123], v7 offset:192
    ds_read_b128 v[124:127], v7 offset:224
    v_mul_f32 v40, v12, v14
    v_mul_f32 v41, v13, v14
    v_add_f32 v40, v40, v40
    v_add_f32 v41, v41, v41
    s_mov_b32 m0, s65
    s_waitcnt lgkmcnt(7)
    buffer_store_dwordx4 v[224:227], v6, s[40:43], s60 offen sc1
    buffer_store_dwordx4 v[228:231], v6, s[40:43], s60 offen offset:128 sc1
    ds_read_b128 v[128:131], v7 offset:8704
    ds_read_b128 v[132:135], v7 offset:8736
    ds_read_b128 v[136:139], v7 offset:8768
    ds_read_b128 v[140:143], v7 offset:8800
    ds_read_b128 v[144:147], v7 offset:8832
    ds_read_b128 v[148:151], v7 offset:8864
    ds_read_b128 v[152:155], v7 offset:8896
    ds_read_b128 v[156:159], v7 offset:8928
    v_exp_f32 v32, -v10
    v_fract_f32 v33, v11
    v_mul_f32 v34, s63, v10
    v_mul_f32 v35, s63, v11
    v_exp_f32 v34, -v34
    v_fract_f32 v35, v35
    v_cos_f32 v20, v33
    v_sin_f32 v21, v33
    v_cos_f32 v24, v35
    v_sin_f32 v25, v35
    v_mul_f32 v20, v32, v20
    v_mul_f32 v21, v32, v21
    v_mul_f32 v24, v34, v24
    v_mul_f32 v25, v34, v25
    v_mul_f32 v32, v41, v21
    v_mul_f32 v33, v40, v21
    v_mul_f32 v34, v21, v21
    v_mul_f32 v35, v20, v21
    v_fma_f32 v42, v40, v20, -v32
    v_fma_f32 v43, v41, v20, v33
    v_fma_f32 v22, v20, v20, -v34
    v_fma_f32 v23, v21, v20, v35
    v_mul_f32 v32, v41, v23
    v_mul_f32 v33, v40, v23
    v_mul_f32 v34, v43, v23
    v_mul_f32 v35, v42, v23
    v_mul_f32 v36, v23, v23
    v_mul_f32 v37, v22, v23
    v_mul_f32 v38, v25, v25
    v_mul_f32 v39, v24, v25
    v_fma_f32 v44, v40, v22, -v32
    v_fma_f32 v45, v41, v22, v33
    v_fma_f32 v46, v42, v22, -v34
    v_fma_f32 v47, v43, v22, v35
    v_fma_f32 v26, v22, v22, -v36
    v_fma_f32 v27, v23, v22, v37
    v_fma_f32 v30, v24, v24, -v38
    v_fma_f32 v31, v25, v24, v39
    v_mul_f32 v32, v41, v27
    v_mul_f32 v33, v40, v27
    v_mul_f32 v34, v43, v27
    v_mul_f32 v35, v42, v27
    v_mul_f32 v36, v45, v27
    v_mul_f32 v37, v44, v27
    v_mul_f32 v38, v47, v27
    v_mul_f32 v39, v46, v27
    v_fma_f32 v48, v40, v26, -v32
    v_fma_f32 v49, v41, v26, v33
    v_fma_f32 v50, v42, v26, -v34
    v_fma_f32 v51, v43, v26, v35
    v_fma_f32 v52, v44, v26, -v36
    v_fma_f32 v53, v45, v26, v37
    v_fma_f32 v54, v46, v26, -v38
    v_fma_f32 v55, v47, v26, v39
    v_mul_f32 v32, v49, v27
    v_mul_f32 v33, v48, v27
    v_fma_f32 v28, v48, v26, -v32
    v_fma_f32 v29, v49, v26, v33
    v_cvt_pk_bf16_f32 v59, v40, -v41
    v_cvt_pk_bf16_f32 v60, v42, -v43
    v_cvt_pk_bf16_f32 v61, v44, -v45
    v_cvt_pk_bf16_f32 v62, v46, -v47
    v_cvt_pk_bf16_f32 v63, v48, -v49
    v_cvt_pk_bf16_f32 v64, v50, -v51
    v_cvt_pk_bf16_f32 v65, v52, -v53
    v_cvt_pk_bf16_f32 v66, v54, -v55
    v_mul_f32 v32, v41, v25
    v_mul_f32 v33, v40, v25
    v_mul_f32 v34, v45, v25
    v_mul_f32 v35, v44, v25
    v_mul_f32 v36, v49, v25
    v_mul_f32 v37, v48, v25
    v_mul_f32 v38, v53, v25
    v_mul_f32 v39, v52, v25
    v_mul_f32 v16, v29, v25
    v_mul_f32 v17, v28, v25
    v_fma_f32 v40, v40, v24, -v32
    v_fma_f32 v41, v41, v24, v33
    s_waitcnt lgkmcnt(0)
    s_barrier
    v_fma_f32 v44, v44, v24, -v34
    ds_write_addtid_b32 v59 offset:0
    ds_write_addtid_b32 v60 offset:272
    ds_write_addtid_b32 v61 offset:544
    ds_write_addtid_b32 v62 offset:816
    ds_write_addtid_b32 v63 offset:1088
    ds_write_addtid_b32 v64 offset:1360
    ds_write_addtid_b32 v65 offset:1632
    ds_write_addtid_b32 v66 offset:1904
    v_fma_f32 v45, v45, v24, v35
    v_fma_f32 v48, v48, v24, -v36
    v_fma_f32 v49, v49, v24, v37
    v_fma_f32 v52, v52, v24, -v38
    v_fma_f32 v53, v53, v24, v39
    v_fma_f32 v28, v28, v24, -v16
    v_fma_f32 v29, v29, v24, v17
    v_cvt_pk_bf16_f32 v67, v40, -v41
    v_cvt_pk_bf16_f32 v68, v44, -v45
    v_cvt_pk_bf16_f32 v69, v48, -v49
    v_cvt_pk_bf16_f32 v70, v52, -v53
    v_cvt_pk_bf16_f32 v71, v28, -v29
    v_mul_f32 v32, v41, v25
    v_mul_f32 v33, v40, v25
    v_mul_f32 v34, v49, v25
    v_mul_f32 v35, v48, v25
    v_mul_f32 v36, v29, v25
    v_mul_f32 v37, v28, v25
    v_fma_f32 v40, v40, v24, -v32
    v_fma_f32 v41, v41, v24, v33
    v_fma_f32 v48, v48, v24, -v34
    v_fma_f32 v49, v49, v24, v35
    v_fma_f32 v28, v28, v24, -v36
    v_fma_f32 v29, v29, v24, v37
    v_cvt_pk_bf16_f32 v72, v40, -v41
    v_cvt_pk_bf16_f32 v73, v48, -v49
    v_cvt_pk_bf16_f32 v74, v28, -v29
    ds_write_addtid_b32 v67 offset:2176
    ds_write_addtid_b32 v68 offset:2448
    ds_write_addtid_b32 v69 offset:2720
    ds_write_addtid_b32 v70 offset:2992
    ds_write_addtid_b32 v71 offset:3264
    ds_write_addtid_b32 v72 offset:3536
    ds_write_addtid_b32 v73 offset:3808
    ds_write_addtid_b32 v74 offset:4080
    v_mul_f32 v32, v41, v25
    v_mul_f32 v33, v40, v25
    v_mul_f32 v34, v49, v25
    v_mul_f32 v35, v48, v25
    v_mul_f32 v36, v29, v25
    v_mul_f32 v37, v28, v25
    v_fma_f32 v40, v40, v24, -v32
    v_fma_f32 v41, v41, v24, v33
    v_fma_f32 v48, v48, v24, -v34
    v_fma_f32 v49, v49, v24, v35
    v_fma_f32 v28, v28, v24, -v36
    v_fma_f32 v29, v29, v24, v37
    v_cvt_pk_bf16_f32 v75, v40, -v41
    v_cvt_pk_bf16_f32 v76, v48, -v49
    v_cvt_pk_bf16_f32 v77, v28, -v29
    v_mul_f32 v32, v41, v25
    v_mul_f32 v33, v40, v25
    v_mul_f32 v34, v29, v25
    v_mul_f32 v35, v28, v25
    v_fma_f32 v42, v40, v24, -v32
    v_fma_f32 v43, v41, v24, v33
    v_fma_f32 v46, v28, v24, -v34
    v_fma_f32 v47, v29, v24, v35
    v_mul_f32 v32, v43, v25
    v_mul_f32 v33, v42, v25
    v_mul_f32 v34, v47, v25
    v_mul_f32 v35, v46, v25
    v_mul_f32 v36, v43, v31
    v_mul_f32 v37, v42, v31
    v_mul_f32 v38, v47, v31
    v_mul_f32 v39, v46, v31
    v_fma_f32 v50, v42, v24, -v32
    v_fma_f32 v51, v43, v24, v33
    v_fma_f32 v52, v46, v24, -v34
    v_fma_f32 v53, v47, v24, v35
    v_fma_f32 v40, v42, v30, -v36
    v_fma_f32 v41, v43, v30, v37
    v_fma_f32 v28, v46, v30, -v38
    v_fma_f32 v29, v47, v30, v39
    v_mul_f32 v32, v51, v31
    v_mul_f32 v33, v50, v31
    v_mul_f32 v34, v53, v31
    v_mul_f32 v35, v52, v31
    v_fma_f32 v44, v50, v30, -v32
    v_fma_f32 v45, v51, v30, v33
    v_fma_f32 v48, v52, v30, -v34
    v_fma_f32 v49, v53, v30, v35
    v_cvt_pk_bf16_f32 v78, v42, -v43
    v_cvt_pk_bf16_f32 v79, v46, -v47
    v_cvt_pk_bf16_f32 v80, v50, -v51
    v_cvt_pk_bf16_f32 v81, v52, -v53
    v_cvt_pk_bf16_f32 v82, v40, -v41
    ds_write_addtid_b32 v75 offset:4352
    ds_write_addtid_b32 v76 offset:4624
    ds_write_addtid_b32 v77 offset:4896
    ds_write_addtid_b32 v78 offset:5168
    ds_write_addtid_b32 v79 offset:5440
    ds_write_addtid_b32 v80 offset:5712
    ds_write_addtid_b32 v81 offset:5984
    ds_write_addtid_b32 v82 offset:6256
    v_cvt_pk_bf16_f32 v83, v28, -v29
    v_cvt_pk_bf16_f32 v84, v44, -v45
    v_cvt_pk_bf16_f32 v85, v48, -v49
    ds_write_addtid_b32 v83 offset:6528
    ds_write_addtid_b32 v84 offset:6800
    ds_write_addtid_b32 v85 offset:7072
    s_waitcnt vmcnt(0)
    s_mov_b64 exec, 1
    buffer_store_dwordx2 v[240:241], v242, s[40:43], s61 offen sc1
    s_mov_b64 exec, -1
    s_waitcnt lgkmcnt(0)
    s_setprio 0
    s_barrier
    ds_read_b128 v[160:163], v9 offset:0
    ds_read_b128 v[164:167], v9 offset:32
    ds_read_b128 v[168:171], v9 offset:64
    ds_read_b128 v[172:175], v9 offset:96
    ds_read_b128 v[176:179], v9 offset:128
    ds_read_b128 v[180:183], v9 offset:160
    ds_read_b128 v[184:187], v9 offset:192
    ds_read_b128 v[188:191], v9 offset:224
    ds_read_b128 v[192:195], v9 offset:7344
    ds_read_b128 v[196:199], v9 offset:7376
    ds_read_b128 v[200:203], v9 offset:7408
    ds_read_b128 v[204:207], v9 offset:7440
    v_lshlrev_b32 v1, 4, v0
    v_mov_b32 v60, 0
    v_mov_b32 v61, 0
    v_mov_b32 v62, 0
    v_mov_b32 v63, 0
    s_mul_i32 s67, s52, 4608
    s_add_u32 s67, s67, 16384
    v_mov_b32 v3, s67
    s_lshl_b32 s66, s53, 11
    s_add_u32 s66, s66, s67
    v_lshrrev_b32 v2, 5, v0
    v_and_b32 v4, 31, v0
    v_lshlrev_b32 v4, 4, v4
    v_lshl_add_u32 v2, v2, 9, v4
    v_add_u32 v2, s66, v2
    s_waitcnt lgkmcnt(4)
    ds_read_b128 v[208:211], v9 offset:7472
    ds_read_b128 v[212:215], v9 offset:7504
    ds_read_b128 v[216:219], v9 offset:7536
    ds_read_b128 v[220:223], v9 offset:7568
    v_mfma_f32_32x32x16_bf16 v[224:239], v[160:163], v[96:99], 0
    v_mfma_f32_32x32x16_bf16 v[224:239], v[164:167], v[100:103], v[224:239]
    v_mfma_f32_32x32x16_bf16 v[224:239], v[168:171], v[104:107], v[224:239]
    v_mfma_f32_32x32x16_bf16 v[224:239], v[172:175], v[108:111], v[224:239]
    v_mfma_f32_32x32x16_bf16 v[224:239], v[176:179], v[112:115], v[224:239]
    v_mfma_f32_32x32x16_bf16 v[224:239], v[180:183], v[116:119], v[224:239]
    v_mfma_f32_32x32x16_bf16 v[224:239], v[184:187], v[120:123], v[224:239]
    v_mfma_f32_32x32x16_bf16 v[224:239], v[188:191], v[124:127], v[224:239]
    s_waitcnt lgkmcnt(0)
    s_barrier
    v_mfma_f32_32x32x16_bf16 v[224:239], v[192:195], v[128:131], v[224:239]
    s_lshr_b32 s74, s49, 3
    s_lshl_b32 s75, s48, 2
    s_add_u32 s74, s74, s75
    s_and_b32 s75, s49, 7
    s_lshl_b32 s76, s75, 3
    s_add_u32 s76, s76, s50
    s_lshl_b32 s77, s74, 6
    v_mfma_f32_32x32x16_bf16 v[224:239], v[196:199], v[132:135], v[224:239]
    s_add_u32 s77, s77, s76
    s_lshl_b32 s77, s77, 10
    s_add_u32 s77, s77, 0
    s_lshl_b32 s78, s74, 17
    s_lshl_b32 s79, s50, 10
    s_add_u32 s78, s78, s79
    s_add_u32 s78, s78, 2097152
    v_mfma_f32_32x32x16_bf16 v[224:239], v[200:203], v[136:139], v[224:239]
    s_mov_b32 s82, 0xffff
    s_mov_b32 s83, 0xffff
    v_and_b32 v16, 27, v0
    v_cmp_eq_u32 vcc, 16, v16
    v_mov_b32 v17, 0x3f803f80
    v_mov_b32 v92, 163836
    v_cndmask_b32 v16, 0, v17, vcc
    v_mfma_f32_32x32x16_bf16 v[224:239], v[204:207], v[140:143], v[224:239]
    v_mov_b32 v93, 1
    v_mov_b32 v17, v16
    v_mov_b32 v18, v16
    v_mov_b32 v19, v16
    v_mov_b32 v20, v16
    v_mov_b32 v21, v16
    v_mov_b32 v22, v16
    v_mfma_f32_32x32x16_bf16 v[224:239], v[208:211], v[144:147], v[224:239]
    v_mov_b32 v23, v16
    v_mov_b32 v24, v16
    v_mov_b32 v25, v16
    v_mov_b32 v26, v16
    v_mov_b32 v27, v16
    v_mov_b32 v28, v16
    v_mov_b32 v29, v16
    v_mfma_f32_32x32x16_bf16 v[224:239], v[212:215], v[148:151], v[224:239]
    v_mov_b32 v30, v16
    v_mov_b32 v31, v16
    v_mov_b32 v64, 0
    v_mov_b32 v65, 0
    v_mov_b32 v66, 0
    v_mov_b32 v67, 0
    v_mov_b32 v68, 0
    v_mfma_f32_32x32x16_bf16 v[224:239], v[216:219], v[152:155], v[224:239]
    v_mov_b32 v69, 0
    v_mov_b32 v70, 0
    v_mov_b32 v71, 0
    v_mov_b32 v72, 0
    v_mov_b32 v73, 0
    v_mov_b32 v74, 0
    v_mov_b32 v75, 0
    v_mfma_f32_32x32x16_bf16 v[224:239], v[220:223], v[156:159], v[224:239]
    v_mov_b32 v76, 0
    v_mov_b32 v77, 0
    v_mov_b32 v78, 0
    v_mov_b32 v79, 0
    ds_write_b128 v3, v[60:63]
    s_nop 6
    v_cndmask_b32 v228, v228, v229, s[70:71]
    v_cndmask_b32 v236, v236, v237, s[70:71]
    v_cvt_pk_bf16_f32 v40, v224, v225
    v_cvt_pk_bf16_f32 v41, v226, v227
    v_cvt_pk_bf16_f32 v42, v228, v229
    v_cvt_pk_bf16_f32 v43, v230, v231
    v_cvt_pk_bf16_f32 v44, v232, v233
    v_cvt_pk_bf16_f32 v45, v234, v235
    v_cvt_pk_bf16_f32 v46, v236, v237
    v_cvt_pk_bf16_f32 v47, v238, v239
    ds_write_b128 v2, v[40:43] offset:16
    ds_write_b128 v2, v[44:47] offset:1040
    s_waitcnt lgkmcnt(0)
    s_barrier
    v_and_b32 v55, 31, v0
    v_lshlrev_b32 v55, 3, v55
    buffer_load_dword v244, v55, s[40:43], s72 offen sc1
    v_add_u32 v2, s66, v1
    ds_read_b64 v[40:41], v2 offset:8
    ds_read_b128 v[42:45], v2 offset:16
    ds_read_b64 v[46:47], v2 offset:1032
    ds_read_b128 v[48:51], v2 offset:1040
    s_cmp_eq_u32 s52, 0
    s_cselect_b32 s67, 0, 65536
    v_bfe_u32 v2, v0, 2, 2
    v_mul_u32_u24 v2, 4160, v2
    v_and_b32 v3, 3, v0
    v_min_u32 v3, 2, v3
    v_lshl_add_u32 v2, v3, 4, v2
    v_add_u32 v52, s67, v2
    s_lshl_b32 s69, s53, 11
    s_sub_u32 s66, s67, s69
    s_add_u32 s66, s66, 3056
    v_sub_u32 v53, s66, v1
    v_min_u32 v2, 32, v0
    s_mul_i32 s66, s53, 4640
    s_add_u32 s66, s66, s67
    s_add_u32 s66, s66, 16640
    v_lshl_add_u32 v54, v2, 4, s66
    s_mov_b32 s69, 0xffff
    s_waitcnt lgkmcnt(0)
    v_bfi_b32 v96, s69, v44, v43
    v_bfi_b32 v97, s69, v43, v42
    v_bfi_b32 v98, s69, v42, v41
    v_bfi_b32 v99, s69, v41, v40
    v_alignbit_b32 v100, v44, v44, 16
    v_alignbit_b32 v101, v43, v43, 16
    v_alignbit_b32 v102, v42, v42, 16
    v_alignbit_b32 v103, v41, v41, 16
    v_bfi_b32 v104, s69, v45, v44
    v_bfi_b32 v105, s69, v44, v43
    v_bfi_b32 v106, s69, v43, v42
    v_bfi_b32 v107, s69, v42, v41
    v_alignbit_b32 v108, v45, v45, 16
    v_alignbit_b32 v109, v44, v44, 16
    v_alignbit_b32 v110, v43, v43, 16
    v_alignbit_b32 v111, v42, v42, 16
    v_bfi_b32 v112, s69, v50, v49
    v_bfi_b32 v113, s69, v49, v48
    v_bfi_b32 v114, s69, v48, v47
    v_bfi_b32 v115, s69, v47, v46
    v_alignbit_b32 v116, v50, v50, 16
    v_alignbit_b32 v117, v49, v49, 16
    v_alignbit_b32 v118, v48, v48, 16
    v_alignbit_b32 v119, v47, v47, 16
    v_bfi_b32 v120, s69, v51, v50
    v_bfi_b32 v121, s69, v50, v49
    v_bfi_b32 v122, s69, v49, v48
    v_bfi_b32 v123, s69, v48, v47
    v_alignbit_b32 v124, v51, v51, 16
    v_alignbit_b32 v125, v50, v50, 16
    v_alignbit_b32 v126, v49, v49, 16
    v_alignbit_b32 v127, v48, v48, 16
    v_lshlrev_b32 v1, 4, v0
    v_mov_b32 v60, 0
    s_lshl_b32 s66, s51, 2
    s_add_u32 s66, s66, 32000
    v_mov_b32 v59, s66
    ds_write_b32 v59, v60
    s_lshl_b32 s71, s48, 18
    s_lshl_b32 s69, s49, 13
    s_add_u32 s71, s71, s69
    s_lshl_b32 s69, s52, 6
    s_add_u32 s71, s71, s69
    s_lshl_b32 s69, s53, 12
    s_add_u32 s71, s71, s69
    s_add_u32 s71, s71, 6291456
    v_lshrrev_b32 v2, 2, v0
    v_and_b32 v3, 3, v0
    v_lshlrev_b32 v3, 4, v3
    v_lshl_add_u32 v56, v2, 7, v3
    s_lshl_b32 s70, s53, 11
    s_add_u32 s69, s67, s70
    s_add_u32 s69, s69, 17152
    v_add_u32 v57, s69, v1
    s_lshl_b32 s73, s53, 8
    s_sub_u32 s73, s67, s73
    s_add_u32 s66, s73, 352
    v_and_b32 v4, 3, v0
    v_mul_u32_u24 v4, 4160, v4
    v_lshrrev_b32 v2, 4, v0
    v_bfe_u32 v3, v0, 2, 2
    v_add_u32 v3, v3, v2
    v_lshlrev_b32 v3, 4, v3
    v_sub_u32 v4, v4, v3
    v_add_u32 v86, s66, v4
    s_add_u32 s66, s73, 21648
    v_bfe_u32 v4, v0, 1, 3
    v_lshlrev_b32 v4, 6, v4
    v_lshlrev_b32 v3, 4, v2
    v_sub_u32 v5, v4, v3
    v_add_u32 v4, v4, v3
    v_and_b32 v3, 1, v0
    v_lshl_add_u32 v4, v3, 3, v4
    v_mul_u32_u24 v3, 4640, v3
    v_sub_u32 v5, v5, v3
    v_add_u32 v87, s66, v5
    v_add_u32 v88, s69, v4
    v_add_u32 v232, s70, v4
    v_add_u32 v233, 512, v232
    v_add_u32 v234, 1024, v232
    v_add_u32 v235, 1536, v232
    s_lshl_b32 s66, s51, 12
    s_add_u32 s66, s66, 131072
    v_add_u32 v91, s66, v1
    s_lshl_b32 s66, s54, 12
    s_add_u32 s66, s66, 8388608
    v_lshlrev_b32 v1, 4, v0
    v_lshrrev_b32 v2, 5, v0
    v_lshlrev_b32 v2, 8, v2
    v_and_b32 v3, 15, v0
    v_lshl_add_u32 v2, v3, 4, v2
    v_add_u32 v2, 1024, v2
    v_add_u32 v80, 0x10000, v1
    v_add_u32 v81, 0x10000, v2
    v_mov_b32 v3, 0xdddddddd
    s_waitcnt lgkmcnt(0)
    s_barrier
    s_waitcnt vmcnt(0)
    v_cmp_ne_u32 s[94:95], v244, v240
    s_nop 1
    s_cmp_lg_u64 s[94:95], 0
    s_cbranch_scc1 L_u_skip
    buffer_load_dwordx4 v[32:35], v56, s[40:43], s71 offen offset:0 sc1
    buffer_load_dwordx4 v[36:39], v56, s[40:43], s71 offen offset:2048 sc1
L_u_skip:
    s_lshl_b32 s60, s48, 2
    s_lshl_b32 s61, s52, 1
    s_add_u32 s60, s60, s61
    s_lshl_b32 s60, s60, 6
    s_lshl_b32 s61, s49, 1
    s_add_u32 s61, s61, s53
    s_add_u32 s60, s60, s61
    s_lshl_b32 s61, s60, 10
    s_add_u32 s61, s61, 0
    s_lshl_b32 s60, s60, 11
    s_add_u32 s60, s60, 2097152
    v_and_b32 v85, 7, v0
    v_lshlrev_b32 v85, 7, v85
    v_bfe_u32 v84, v0, 3, 1
    v_lshl_add_u32 v58, v84, 16, v85
    v_lshl_add_u32 v85, v84, 17, v85
    s_mov_b64 exec, 0xffff
    buffer_load_dword v84, v58, s[40:43], s61 offen offset:0 sc1
    s_mov_b64 exec, -1
    ds_write_b128 v52, v[60:63] offset:4096
    ds_write_b128 v54, v[60:63]
    ds_write_b128 v53, v[96:99] offset:1024
    ds_write_b128 v53, v[100:103] offset:5184
    ds_write_b128 v53, v[104:107] offset:9344
    ds_write_b128 v53, v[108:111] offset:13504
    ds_write_b128 v53, v[112:115] offset:0
    s_waitcnt lgkmcnt(0)
    s_barrier
    ds_write_b128 v53, v[116:119] offset:4160
    ds_write_b128 v53, v[120:123] offset:8320
    ds_write_b128 v53, v[124:127] offset:12480
    s_barrier
    s_cmp_lg_u64 s[94:95], 0
    s_cbranch_scc0 L_u_have
    s_mov_b32 s92, 400000
L_s1_poll:
    buffer_load_dword v244, v55, s[40:43], s72 offen sc1
    s_waitcnt vmcnt(0)
L_s1_chk:
    v_cmp_ne_u32 vcc, v244, v240
    s_nop 1
    s_cbranch_vccz L_s1_ok
    s_sleep 4
    s_sub_u32 s92, s92, 1
    s_cmp_lg_u32 s92, 0
    s_cbranch_scc1 L_s1_poll
L_s1_ok:
    buffer_load_dwordx4 v[32:35], v56, s[40:43], s71 offen offset:0 sc1
    buffer_load_dwordx4 v[36:39], v56, s[40:43], s71 offen offset:2048 sc1
    s_waitcnt vmcnt(0)
L_u_have:
    s_waitcnt vmcnt(1)
    ds_write_b128 v57, v[32:35] offset:0
    ds_write_b128 v57, v[36:39] offset:1024
    ds_write_b64 v57, v[32:33] offset:4648
    ds_write_b64 v57, v[34:35] offset:4656
    ds_write_b64 v57, v[36:37] offset:5672
    ds_write_b64 v57, v[38:39] offset:5680
    ds_write_b32 v59, v59
    v_xor_b32 v59, 4, v59
    s_mov_b32 s92, 8000000
L_pair:
    ds_read_b32 v57, v59
    s_waitcnt lgkmcnt(0)
    v_readfirstlane_b32 s93, v57
    s_sub_u32 s92, s92, 1
    s_cmp_eq_u32 s92, 0
    s_cbranch_scc1 L_pair_ok
    s_cmp_eq_u32 s93, 0
    s_cbranch_scc1 L_pair
L_pair_ok:
    ds_read_b128 v[96:99], v86 offset:3776
    ds_read_b128 v[128:131], v87 offset:192
    ds_read_b128 v[100:103], v86 offset:3264
    ds_read_b128 v[132:135], v87 offset:704
    ds_read_b128 v[104:107], v86 offset:2752
    ds_read_b128 v[136:139], v87 offset:1216
    ds_read_b128 v[108:111], v86 offset:2240
    ds_read_b128 v[140:143], v87 offset:1728
    ds_read_b128 v[112:115], v86 offset:1728
    ds_read_b128 v[144:147], v87 offset:2240
    ds_read_b128 v[116:119], v86 offset:1216
    ds_read_b128 v[148:151], v87 offset:2752
    ds_read_b128 v[120:123], v86 offset:704
    ds_read_b128 v[152:155], v87 offset:3264
    ds_read_b128 v[124:127], v86 offset:192
    s_waitcnt lgkmcnt(14)
    ds_read_b128 v[156:159], v87 offset:3776
    s_waitcnt lgkmcnt(14)
    v_mfma_f32_16x16x32_bf16 v[32:35], v[96:99], v[128:131], 0
    s_waitcnt lgkmcnt(13)
    v_mfma_f32_16x16x32_bf16 v[36:39], v[100:103], v[128:131], 0
    s_waitcnt lgkmcnt(12)
    v_mfma_f32_16x16x32_bf16 v[36:39], v[96:99], v[132:135], v[36:39]
    v_mfma_f32_16x16x32_bf16 v[40:43], v[100:103], v[132:135], 0
    s_waitcnt lgkmcnt(11)
    v_mfma_f32_16x16x32_bf16 v[40:43], v[104:107], v[128:131], v[40:43]
    v_mfma_f32_16x16x32_bf16 v[44:47], v[104:107], v[132:135], 0
    s_waitcnt lgkmcnt(10)
    v_mfma_f32_16x16x32_bf16 v[40:43], v[96:99], v[136:139], v[40:43]
    v_mfma_f32_16x16x32_bf16 v[44:47], v[100:103], v[136:139], v[44:47]
    v_mfma_f32_16x16x32_bf16 v[48:51], v[104:107], v[136:139], 0
    s_waitcnt lgkmcnt(9)
    v_mfma_f32_16x16x32_bf16 v[44:47], v[108:111], v[128:131], v[44:47]
    v_mfma_f32_16x16x32_bf16 v[48:51], v[108:111], v[132:135], v[48:51]
    v_mfma_f32_16x16x32_bf16 v[52:55], v[108:111], v[136:139], 0
    s_waitcnt lgkmcnt(8)
    v_mfma_f32_16x16x32_bf16 v[44:47], v[96:99], v[140:143], v[44:47]
    v_mfma_f32_16x16x32_bf16 v[48:51], v[100:103], v[140:143], v[48:51]
    v_mfma_f32_16x16x32_bf16 v[52:55], v[104:107], v[140:143], v[52:55]
    ds_read_b128 v[160:163], v86 offset:3712
    ds_read_b128 v[192:195], v87 offset:128
    v_mfma_f32_16x16x32_bf16 v[56:59], v[108:111], v[140:143], 0
    s_waitcnt lgkmcnt(9)
    v_mfma_f32_16x16x32_bf16 v[48:51], v[112:115], v[128:131], v[48:51]
    ds_read_b128 v[164:167], v86 offset:3200
    ds_read_b128 v[196:199], v87 offset:640
    v_mfma_f32_16x16x32_bf16 v[52:55], v[112:115], v[132:135], v[52:55]
    v_mfma_f32_16x16x32_bf16 v[56:59], v[112:115], v[136:139], v[56:59]
    ds_read_b128 v[168:171], v86 offset:2688
    ds_read_b128 v[200:203], v87 offset:1152
    v_mfma_f32_16x16x32_bf16 v[60:63], v[112:115], v[140:143], 0
    s_waitcnt lgkmcnt(12)
    v_mfma_f32_16x16x32_bf16 v[48:51], v[96:99], v[144:147], v[48:51]
    ds_read_b128 v[172:175], v86 offset:2176
    ds_read_b128 v[204:207], v87 offset:1664
    v_mfma_f32_16x16x32_bf16 v[52:55], v[100:103], v[144:147], v[52:55]
    v_mfma_f32_16x16x32_bf16 v[56:59], v[104:107], v[144:147], v[56:59]
    ds_read_b128 v[176:179], v86 offset:1664
    s_waitcnt lgkmcnt(14)
    ds_read_b128 v[208:211], v87 offset:2176
    v_mfma_f32_16x16x32_bf16 v[60:63], v[108:111], v[144:147], v[60:63]
    v_mfma_f32_16x16x32_bf16 v[52:55], v[116:119], v[128:131], v[52:55]
    s_waitcnt lgkmcnt(14)
    ds_read_b128 v[180:183], v86 offset:1152
    s_waitcnt lgkmcnt(14)
    ds_read_b128 v[212:215], v87 offset:2688
    v_mfma_f32_16x16x32_bf16 v[56:59], v[116:119], v[132:135], v[56:59]
    v_mfma_f32_16x16x32_bf16 v[60:63], v[116:119], v[136:139], v[60:63]
    s_waitcnt lgkmcnt(14)
    ds_read_b128 v[184:187], v86 offset:640
    s_waitcnt lgkmcnt(14)
    ds_read_b128 v[216:219], v87 offset:3200
    v_mfma_f32_16x16x32_bf16 v[52:55], v[96:99], v[148:151], v[52:55]
    v_mfma_f32_16x16x32_bf16 v[56:59], v[100:103], v[148:151], v[56:59]
    s_waitcnt lgkmcnt(14)
    ds_read_b128 v[188:191], v86 offset:128
    s_waitcnt lgkmcnt(14)
    ds_read_b128 v[220:223], v87 offset:3712
    v_mfma_f32_16x16x32_bf16 v[60:63], v[104:107], v[148:151], v[60:63]
    v_mfma_f32_16x16x32_bf16 v[56:59], v[120:123], v[128:131], v[56:59]
    v_mfma_f32_16x16x32_bf16 v[60:63], v[120:123], v[132:135], v[60:63]
    v_mfma_f32_16x16x32_bf16 v[56:59], v[96:99], v[152:155], v[56:59]
    v_mfma_f32_16x16x32_bf16 v[60:63], v[100:103], v[152:155], v[60:63]
    v_mfma_f32_16x16x32_bf16 v[60:63], v[124:127], v[128:131], v[60:63]
    v_mfma_f32_16x16x32_bf16 v[60:63], v[96:99], v[156:159], v[60:63]
    s_waitcnt lgkmcnt(0)
    v_mfma_f32_16x16x32_bf16 v[32:35], v[160:163], v[192:195], v[32:35]
    ds_read_b128 v[96:99], v86 offset:3648
    ds_read_b128 v[128:131], v87 offset:64
    v_mfma_f32_16x16x32_bf16 v[36:39], v[164:167], v[192:195], v[36:39]
    v_mfma_f32_16x16x32_bf16 v[36:39], v[160:163], v[196:199], v[36:39]
    ds_read_b128 v[100:103], v86 offset:3136
    ds_read_b128 v[132:135], v87 offset:576
    v_mfma_f32_16x16x32_bf16 v[40:43], v[164:167], v[196:199], v[40:43]
    v_mfma_f32_16x16x32_bf16 v[40:43], v[168:171], v[192:195], v[40:43]
    ds_read_b128 v[104:107], v86 offset:2624
    ds_read_b128 v[136:139], v87 offset:1088
    v_mfma_f32_16x16x32_bf16 v[44:47], v[168:171], v[196:199], v[44:47]
    v_mfma_f32_16x16x32_bf16 v[40:43], v[160:163], v[200:203], v[40:43]
    ds_read_b128 v[108:111], v86 offset:2112
    ds_read_b128 v[140:143], v87 offset:1600
    v_mfma_f32_16x16x32_bf16 v[44:47], v[164:167], v[200:203], v[44:47]
    v_mfma_f32_16x16x32_bf16 v[48:51], v[168:171], v[200:203], v[48:51]
    ds_read_b128 v[112:115], v86 offset:1600
    ds_read_b128 v[144:147], v87 offset:2112
    v_mfma_f32_16x16x32_bf16 v[44:47], v[172:175], v[192:195], v[44:47]
    v_mfma_f32_16x16x32_bf16 v[48:51], v[172:175], v[196:199], v[48:51]
    ds_read_b128 v[116:119], v86 offset:1088
    ds_read_b128 v[148:151], v87 offset:2624
    v_mfma_f32_16x16x32_bf16 v[52:55], v[172:175], v[200:203], v[52:55]
    v_mfma_f32_16x16x32_bf16 v[44:47], v[160:163], v[204:207], v[44:47]
    ds_read_b128 v[120:123], v86 offset:576
    ds_read_b128 v[152:155], v87 offset:3136
    v_mfma_f32_16x16x32_bf16 v[48:51], v[164:167], v[204:207], v[48:51]
    v_mfma_f32_16x16x32_bf16 v[52:55], v[168:171], v[204:207], v[52:55]
    ds_read_b128 v[124:127], v86 offset:64
    s_waitcnt lgkmcnt(14)
    ds_read_b128 v[156:159], v87 offset:3648
    v_mfma_f32_16x16x32_bf16 v[56:59], v[172:175], v[204:207], v[56:59]
    v_mfma_f32_16x16x32_bf16 v[48:51], v[176:179], v[192:195], v[48:51]
    v_mfma_f32_16x16x32_bf16 v[52:55], v[176:179], v[196:199], v[52:55]
    v_mfma_f32_16x16x32_bf16 v[56:59], v[176:179], v[200:203], v[56:59]
    v_mfma_f32_16x16x32_bf16 v[60:63], v[176:179], v[204:207], v[60:63]
    v_mfma_f32_16x16x32_bf16 v[48:51], v[160:163], v[208:211], v[48:51]
    v_mfma_f32_16x16x32_bf16 v[52:55], v[164:167], v[208:211], v[52:55]
    v_mfma_f32_16x16x32_bf16 v[56:59], v[168:171], v[208:211], v[56:59]
    v_mfma_f32_16x16x32_bf16 v[60:63], v[172:175], v[208:211], v[60:63]
    v_mfma_f32_16x16x32_bf16 v[52:55], v[180:183], v[192:195], v[52:55]
    v_mfma_f32_16x16x32_bf16 v[56:59], v[180:183], v[196:199], v[56:59]
    v_mfma_f32_16x16x32_bf16 v[60:63], v[180:183], v[200:203], v[60:63]
    v_mfma_f32_16x16x32_bf16 v[52:55], v[160:163], v[212:215], v[52:55]
    v_mfma_f32_16x16x32_bf16 v[56:59], v[164:167], v[212:215], v[56:59]
    v_mfma_f32_16x16x32_bf16 v[60:63], v[168:171], v[212:215], v[60:63]
    v_mfma_f32_16x16x32_bf16 v[56:59], v[184:187], v[192:195], v[56:59]
    v_mfma_f32_16x16x32_bf16 v[60:63], v[184:187], v[196:199], v[60:63]
    v_mfma_f32_16x16x32_bf16 v[56:59], v[160:163], v[216:219], v[56:59]
    v_mfma_f32_16x16x32_bf16 v[60:63], v[164:167], v[216:219], v[60:63]
    v_mfma_f32_16x16x32_bf16 v[60:63], v[188:191], v[192:195], v[60:63]
    v_mfma_f32_16x16x32_bf16 v[60:63], v[160:163], v[220:223], v[60:63]
    s_waitcnt lgkmcnt(0)
    v_mfma_f32_16x16x32_bf16 v[32:35], v[96:99], v[128:131], v[32:35]
    ds_read_b128 v[160:163], v86 offset:3584
    ds_read_b128 v[192:195], v87 offset:0
    v_mfma_f32_16x16x32_bf16 v[36:39], v[100:103], v[128:131], v[36:39]
    v_mfma_f32_16x16x32_bf16 v[36:39], v[96:99], v[132:135], v[36:39]
    ds_read_b128 v[164:167], v86 offset:3072
    ds_read_b128 v[196:199], v87 offset:512
    v_mfma_f32_16x16x32_bf16 v[40:43], v[100:103], v[132:135], v[40:43]
    v_mfma_f32_16x16x32_bf16 v[40:43], v[104:107], v[128:131], v[40:43]
    ds_read_b128 v[168:171], v86 offset:2560
    ds_read_b128 v[200:203], v87 offset:1024
    v_mfma_f32_16x16x32_bf16 v[44:47], v[104:107], v[132:135], v[44:47]
    v_mfma_f32_16x16x32_bf16 v[40:43], v[96:99], v[136:139], v[40:43]
    ds_read_b128 v[172:175], v86 offset:2048
    ds_read_b128 v[204:207], v87 offset:1536
    v_mfma_f32_16x16x32_bf16 v[44:47], v[100:103], v[136:139], v[44:47]
    v_mfma_f32_16x16x32_bf16 v[48:51], v[104:107], v[136:139], v[48:51]
    ds_read_b128 v[176:179], v86 offset:1536
    ds_read_b128 v[208:211], v87 offset:2048
    v_mfma_f32_16x16x32_bf16 v[44:47], v[108:111], v[128:131], v[44:47]
    v_mfma_f32_16x16x32_bf16 v[48:51], v[108:111], v[132:135], v[48:51]
    ds_read_b128 v[180:183], v86 offset:1024
    ds_read_b128 v[212:215], v87 offset:2560
    v_mfma_f32_16x16x32_bf16 v[52:55], v[108:111], v[136:139], v[52:55]
    v_mfma_f32_16x16x32_bf16 v[44:47], v[96:99], v[140:143], v[44:47]
    ds_read_b128 v[184:187], v86 offset:512
    ds_read_b128 v[216:219], v87 offset:3072
    v_mfma_f32_16x16x32_bf16 v[48:51], v[100:103], v[140:143], v[48:51]
    v_mfma_f32_16x16x32_bf16 v[52:55], v[104:107], v[140:143], v[52:55]
    ds_read_b128 v[188:191], v86 offset:0
    s_waitcnt lgkmcnt(14)
    ds_read_b128 v[220:223], v87 offset:3584
    v_mfma_f32_16x16x32_bf16 v[56:59], v[108:111], v[140:143], v[56:59]
    v_mfma_f32_16x16x32_bf16 v[48:51], v[112:115], v[128:131], v[48:51]
    v_mfma_f32_16x16x32_bf16 v[52:55], v[112:115], v[132:135], v[52:55]
    v_mfma_f32_16x16x32_bf16 v[56:59], v[112:115], v[136:139], v[56:59]
    v_mfma_f32_16x16x32_bf16 v[60:63], v[112:115], v[140:143], v[60:63]
    v_mfma_f32_16x16x32_bf16 v[48:51], v[96:99], v[144:147], v[48:51]
    v_mfma_f32_16x16x32_bf16 v[52:55], v[100:103], v[144:147], v[52:55]
    v_mfma_f32_16x16x32_bf16 v[56:59], v[104:107], v[144:147], v[56:59]
    v_mfma_f32_16x16x32_bf16 v[60:63], v[108:111], v[144:147], v[60:63]
    v_mfma_f32_16x16x32_bf16 v[52:55], v[116:119], v[128:131], v[52:55]
    v_mfma_f32_16x16x32_bf16 v[56:59], v[116:119], v[132:135], v[56:59]
    v_mfma_f32_16x16x32_bf16 v[60:63], v[116:119], v[136:139], v[60:63]
    v_mfma_f32_16x16x32_bf16 v[52:55], v[96:99], v[148:151], v[52:55]
    v_mfma_f32_16x16x32_bf16 v[56:59], v[100:103], v[148:151], v[56:59]
    v_mfma_f32_16x16x32_bf16 v[60:63], v[104:107], v[148:151], v[60:63]
    v_mfma_f32_16x16x32_bf16 v[56:59], v[120:123], v[128:131], v[56:59]
    v_mfma_f32_16x16x32_bf16 v[60:63], v[120:123], v[132:135], v[60:63]
    v_mfma_f32_16x16x32_bf16 v[56:59], v[96:99], v[152:155], v[56:59]
    v_mfma_f32_16x16x32_bf16 v[60:63], v[100:103], v[152:155], v[60:63]
    v_mfma_f32_16x16x32_bf16 v[60:63], v[124:127], v[128:131], v[60:63]
    v_mfma_f32_16x16x32_bf16 v[60:63], v[96:99], v[156:159], v[60:63]
    s_waitcnt lgkmcnt(0)
    v_mfma_f32_16x16x32_bf16 v[32:35], v[160:163], v[192:195], v[32:35]
    ds_read_b64 v[224:225], v88 offset:0
    ds_read_b64 v[226:227], v88 offset:512
    v_mfma_f32_16x16x32_bf16 v[36:39], v[164:167], v[192:195], v[36:39]
    v_mfma_f32_16x16x32_bf16 v[36:39], v[160:163], v[196:199], v[36:39]
    ds_read_b64 v[228:229], v88 offset:1024
    ds_read_b64 v[230:231], v88 offset:1536
    v_mfma_f32_16x16x32_bf16 v[40:43], v[164:167], v[196:199], v[40:43]
    v_mfma_f32_16x16x32_bf16 v[40:43], v[168:171], v[192:195], v[40:43]
    v_mfma_f32_16x16x32_bf16 v[44:47], v[168:171], v[196:199], v[44:47]
    v_mfma_f32_16x16x32_bf16 v[40:43], v[160:163], v[200:203], v[40:43]
    v_mfma_f32_16x16x32_bf16 v[44:47], v[164:167], v[200:203], v[44:47]
    v_mfma_f32_16x16x32_bf16 v[48:51], v[168:171], v[200:203], v[48:51]
    v_mfma_f32_16x16x32_bf16 v[44:47], v[172:175], v[192:195], v[44:47]
    v_mfma_f32_16x16x32_bf16 v[48:51], v[172:175], v[196:199], v[48:51]
    v_mfma_f32_16x16x32_bf16 v[52:55], v[172:175], v[200:203], v[52:55]
    v_mfma_f32_16x16x32_bf16 v[44:47], v[160:163], v[204:207], v[44:47]
    v_mfma_f32_16x16x32_bf16 v[48:51], v[164:167], v[204:207], v[48:51]
    v_mfma_f32_16x16x32_bf16 v[52:55], v[168:171], v[204:207], v[52:55]
    v_mfma_f32_16x16x32_bf16 v[56:59], v[172:175], v[204:207], v[56:59]
    v_mfma_f32_16x16x32_bf16 v[48:51], v[176:179], v[192:195], v[48:51]
    v_mfma_f32_16x16x32_bf16 v[52:55], v[176:179], v[196:199], v[52:55]
    v_mfma_f32_16x16x32_bf16 v[56:59], v[176:179], v[200:203], v[56:59]
    v_mfma_f32_16x16x32_bf16 v[60:63], v[176:179], v[204:207], v[60:63]
    v_mfma_f32_16x16x32_bf16 v[48:51], v[160:163], v[208:211], v[48:51]
    v_mfma_f32_16x16x32_bf16 v[52:55], v[164:167], v[208:211], v[52:55]
    v_mfma_f32_16x16x32_bf16 v[56:59], v[168:171], v[208:211], v[56:59]
    v_mfma_f32_16x16x32_bf16 v[60:63], v[172:175], v[208:211], v[60:63]
    v_mfma_f32_16x16x32_bf16 v[52:55], v[180:183], v[192:195], v[52:55]
    v_mfma_f32_16x16x32_bf16 v[56:59], v[180:183], v[196:199], v[56:59]
    v_mfma_f32_16x16x32_bf16 v[60:63], v[180:183], v[200:203], v[60:63]
    v_mfma_f32_16x16x32_bf16 v[52:55], v[160:163], v[212:215], v[52:55]
    v_mfma_f32_16x16x32_bf16 v[56:59], v[164:167], v[212:215], v[56:59]
    v_mfma_f32_16x16x32_bf16 v[60:63], v[168:171], v[212:215], v[60:63]
    v_mfma_f32_16x16x32_bf16 v[56:59], v[184:187], v[192:195], v[56:59]
    v_mfma_f32_16x16x32_bf16 v[60:63], v[184:187], v[196:199], v[60:63]
    v_mfma_f32_16x16x32_bf16 v[56:59], v[160:163], v[216:219], v[56:59]
    v_mfma_f32_16x16x32_bf16 v[60:63], v[164:167], v[216:219], v[60:63]
    v_mfma_f32_16x16x32_bf16 v[60:63], v[188:191], v[192:195], v[60:63]
    v_mfma_f32_16x16x32_bf16 v[60:63], v[160:163], v[220:223], v[60:63]
    s_cmp_eq_u32 s53, 0
    s_cbranch_scc0 L_cv_hi
    s_nop 5
    ds_write_b128 v91, v[48:51] offset:0
    ds_write_b128 v91, v[52:55] offset:1024
    ds_write_b128 v91, v[56:59] offset:2048
    ds_write_b128 v91, v[60:63] offset:3072
    s_branch L_cv_sent
L_cv_hi:
    s_nop 5
    ds_write_b128 v91, v[32:35] offset:0
    ds_write_b128 v91, v[36:39] offset:1024
    ds_write_b128 v91, v[40:43] offset:2048
    ds_write_b128 v91, v[44:47] offset:3072
    s_nop 1
    v_mov_b32 v32, v48
    v_mov_b32 v33, v49
    v_mov_b32 v34, v50
    v_mov_b32 v35, v51
    v_mov_b32 v36, v52
    v_mov_b32 v37, v53
    v_mov_b32 v38, v54
    v_mov_b32 v39, v55
    v_mov_b32 v40, v56
    v_mov_b32 v41, v57
    v_mov_b32 v42, v58
    v_mov_b32 v43, v59
    v_mov_b32 v44, v60
    v_mov_b32 v45, v61
    v_mov_b32 v46, v62
    v_mov_b32 v47, v63
L_cv_sent:
    v_xor_b32 v91, 0x1000, v91
    s_waitcnt lgkmcnt(0)
L_att:
    v_mov_b32 v236, -1
    v_mov_b32 v237, -1
    v_mov_b32 v238, -1
    v_mov_b32 v239, -1
    s_barrier
    ds_write_b32 v92, v242
    s_cmp_lt_u32 s50, 4
    s_cbranch_scc1 L_cv_fin
    ds_read_b128 v[96:99], v91 offset:0
    ds_read_b128 v[100:103], v91 offset:1024
    ds_read_b128 v[104:107], v91 offset:2048
    ds_read_b128 v[108:111], v91 offset:3072
    s_add_u32 s68, s79, 143360
    v_add_u32 v4, s68, v1
    ds_read_b128 v[4:7], v4
    s_mov_b32 s68, 0xffff0000
    v_lshlrev_b32 v48, 16, v224
    v_and_b32 v49, s68, v224
    v_lshlrev_b32 v50, 16, v225
    v_and_b32 v51, s68, v225
    v_lshlrev_b32 v52, 16, v226
    v_and_b32 v53, s68, v226
    v_lshlrev_b32 v54, 16, v227
    v_and_b32 v55, s68, v227
    v_lshlrev_b32 v56, 16, v228
    v_and_b32 v57, s68, v228
    v_lshlrev_b32 v58, 16, v229
    v_and_b32 v59, s68, v229
    v_lshlrev_b32 v60, 16, v230
    v_and_b32 v61, s68, v230
    v_lshlrev_b32 v62, 16, v231
    v_and_b32 v63, s68, v231
    v_fmac_f32 v32, v48, v90
    v_fmac_f32 v33, v49, v90
    v_fmac_f32 v34, v50, v90
    v_fmac_f32 v35, v51, v90
    v_fmac_f32 v36, v52, v90
    v_fmac_f32 v37, v53, v90
    v_fmac_f32 v38, v54, v90
    v_fmac_f32 v39, v55, v90
    v_fmac_f32 v40, v56, v90
    v_fmac_f32 v41, v57, v90
    v_fmac_f32 v42, v58, v90
    v_fmac_f32 v43, v59, v90
    v_fmac_f32 v44, v60, v90
    v_fmac_f32 v45, v61, v90
    v_fmac_f32 v46, v62, v90
    v_fmac_f32 v47, v63, v90
    s_waitcnt lgkmcnt(0)
    v_add_f32 v32, v32, v96
    v_add_f32 v33, v33, v97
    v_add_f32 v34, v34, v98
    v_add_f32 v35, v35, v99
    v_add_f32 v36, v36, v100
    v_add_f32 v37, v37, v101
    v_add_f32 v38, v38, v102
    v_add_f32 v39, v39, v103
    v_add_f32 v40, v40, v104
    v_add_f32 v41, v41, v105
    v_add_f32 v42, v42, v106
    v_add_f32 v43, v43, v107
    v_add_f32 v44, v44, v108
    v_add_f32 v45, v45, v109
    v_add_f32 v46, v46, v110
    v_add_f32 v47, v47, v111
    v_cvt_pk_bf16_f32 v224, v32, v33
    v_cvt_pk_bf16_f32 v225, v34, v35
    v_cvt_pk_bf16_f32 v226, v36, v37
    v_cvt_pk_bf16_f32 v227, v38, v39
    v_cvt_pk_bf16_f32 v228, v40, v41
    v_cvt_pk_bf16_f32 v229, v42, v43
    v_cvt_pk_bf16_f32 v230, v44, v45
    v_cvt_pk_bf16_f32 v231, v46, v47
L_cv_fin:
    ds_read_b128 v[8:11], v80 offset:32768
    ds_read_b128 v[12:15], v80 offset:34816
    s_mov_b64 exec, s[82:83]
    ds_read_b128 v[16:19], v81 offset:32768
    ds_read_b128 v[20:23], v81 offset:33280
    s_mov_b64 exec, -1
    s_waitcnt lgkmcnt(3)
    v_mfma_f32_32x32x16_bf16 v[32:47], v[8:11], v[4:7], 0
    s_setprio 3
    s_nop 10
    v_exp_f32 v32, v32
    v_exp_f32 v33, v33
    s_add_u32 m0, s79, 122880
    s_add_u32 s80, s78, 122880
    buffer_load_dwordx4 v1, s[40:43], s80 offen sc1 lds
    s_mov_b64 exec, s[82:83]
    ds_read_b128 v[24:27], v81 offset:34816
    ds_read_b128 v[28:31], v81 offset:35328
    s_mov_b64 exec, -1
    ds_read_b128 v[8:11], v80 offset:36864
    v_exp_f32 v34, v34
    v_exp_f32 v35, v35
    v_exp_f32 v36, v36
    s_waitcnt lgkmcnt(3)
    v_mfma_f32_32x32x16_bf16 v[48:63], v[12:15], v[4:7], 0
    v_exp_f32 v37, v37
    v_exp_f32 v38, v38
    v_exp_f32 v39, v39
    v_exp_f32 v40, v40
    v_exp_f32 v41, v41
    v_smfmac_f32_32x32x32_bf16 v[64:79], v[16:19], v[32:39], v3
    v_exp_f32 v42, v42
    v_exp_f32 v43, v43
    v_exp_f32 v44, v44
    v_exp_f32 v45, v45
    v_exp_f32 v46, v46
    v_exp_f32 v47, v47
    v_exp_f32 v48, v48
    v_exp_f32 v49, v49
    v_smfmac_f32_32x32x32_bf16 v[64:79], v[20:23], v[40:47], v3
    s_add_u32 m0, s79, 0
    s_add_u32 s80, s78, 0
    buffer_load_dwordx4 v1, s[40:43], s80 offen sc1 lds
    s_mov_b64 exec, s[82:83]
    ds_read_b128 v[16:19], v81 offset:36864
    ds_read_b128 v[20:23], v81 offset:37376
    s_mov_b64 exec, -1
    ds_read_b128 v[12:15], v80 offset:38912
    v_exp_f32 v50, v50
    v_exp_f32 v51, v51
    v_exp_f32 v52, v52
    s_waitcnt lgkmcnt(3)
    v_mfma_f32_32x32x16_bf16 v[32:47], v[8:11], v[4:7], 0
    v_exp_f32 v53, v53
    v_exp_f32 v54, v54
    v_exp_f32 v55, v55
    v_exp_f32 v56, v56
    v_exp_f32 v57, v57
    v_smfmac_f32_32x32x32_bf16 v[64:79], v[24:27], v[48:55], v3
    v_exp_f32 v58, v58
    v_exp_f32 v59, v59
    v_exp_f32 v60, v60
    v_exp_f32 v61, v61
    v_exp_f32 v62, v62
    v_exp_f32 v63, v63
    v_exp_f32 v32, v32
    v_exp_f32 v33, v33
    v_smfmac_f32_32x32x32_bf16 v[64:79], v[28:31], v[56:63], v3
    s_add_u32 m0, s79, 8192
    s_add_u32 s80, s78, 8192
    buffer_load_dwordx4 v1, s[40:43], s80 offen sc1 lds
    s_mov_b64 exec, s[82:83]
    ds_read_b128 v[24:27], v81 offset:38912
    ds_read_b128 v[28:31], v81 offset:39424
    s_mov_b64 exec, -1
    ds_read_b128 v[8:11], v80 offset:40960
    v_exp_f32 v34, v34
    v_exp_f32 v35, v35
    v_exp_f32 v36, v36
    s_waitcnt lgkmcnt(3)
    v_mfma_f32_32x32x16_bf16 v[48:63], v[12:15], v[4:7], 0
    v_exp_f32 v37, v37
    v_exp_f32 v38, v38
    v_exp_f32 v39, v39
    v_exp_f32 v40, v40
    v_exp_f32 v41, v41
    v_smfmac_f32_32x32x32_bf16 v[64:79], v[16:19], v[32:39], v3
    v_exp_f32 v42, v42
    v_exp_f32 v43, v43
    v_exp_f32 v44, v44
    v_exp_f32 v45, v45
    v_exp_f32 v46, v46
    v_exp_f32 v47, v47
    v_exp_f32 v48, v48
    v_exp_f32 v49, v49
    v_smfmac_f32_32x32x32_bf16 v[64:79], v[20:23], v[40:47], v3
    s_add_u32 m0, s79, 16384
    s_add_u32 s80, s78, 16384
    buffer_load_dwordx4 v1, s[40:43], s80 offen sc1 lds
    s_mov_b64 exec, s[82:83]
    ds_read_b128 v[16:19], v81 offset:40960
    ds_read_b128 v[20:23], v81 offset:41472
    s_mov_b64 exec, -1
    ds_read_b128 v[12:15], v80 offset:43008
    v_exp_f32 v50, v50
    v_exp_f32 v51, v51
    v_exp_f32 v52, v52
    s_waitcnt lgkmcnt(3)
    v_mfma_f32_32x32x16_bf16 v[32:47], v[8:11], v[4:7], 0
    v_exp_f32 v53, v53
    v_exp_f32 v54, v54
    v_exp_f32 v55, v55
    v_exp_f32 v56, v56
    v_exp_f32 v57, v57
    v_smfmac_f32_32x32x32_bf16 v[64:79], v[24:27], v[48:55], v3
    v_exp_f32 v58, v58
    v_exp_f32 v59, v59
    v_exp_f32 v60, v60
    v_exp_f32 v61, v61
    v_exp_f32 v62, v62
    v_exp_f32 v63, v63
    v_exp_f32 v32, v32
    v_exp_f32 v33, v33
    v_smfmac_f32_32x32x32_bf16 v[64:79], v[28:31], v[56:63], v3
    s_add_u32 m0, s79, 24576
    s_add_u32 s80, s78, 24576
    buffer_load_dwordx4 v1, s[40:43], s80 offen sc1 lds
    s_mov_b64 exec, s[82:83]
    ds_read_b128 v[24:27], v81 offset:43008
    ds_read_b128 v[28:31], v81 offset:43520
    s_mov_b64 exec, -1
    ds_read_b128 v[8:11], v80 offset:45056
    v_exp_f32 v34, v34
    v_exp_f32 v35, v35
    v_exp_f32 v36, v36
    s_waitcnt lgkmcnt(3)
    v_mfma_f32_32x32x16_bf16 v[48:63], v[12:15], v[4:7], 0
    v_exp_f32 v37, v37
    v_exp_f32 v38, v38
    v_exp_f32 v39, v39
    v_exp_f32 v40, v40
    v_exp_f32 v41, v41
    v_smfmac_f32_32x32x32_bf16 v[64:79], v[16:19], v[32:39], v3
    v_exp_f32 v42, v42
    v_exp_f32 v43, v43
    v_exp_f32 v44, v44
    v_exp_f32 v45, v45
    v_exp_f32 v46, v46
    v_exp_f32 v47, v47
    v_exp_f32 v48, v48
    v_exp_f32 v49, v49
    v_smfmac_f32_32x32x32_bf16 v[64:79], v[20:23], v[40:47], v3
    s_add_u32 m0, s79, 32768
    s_add_u32 s80, s78, 32768
    buffer_load_dwordx4 v1, s[40:43], s80 offen sc1 lds
    s_mov_b64 exec, s[82:83]
    ds_read_b128 v[16:19], v81 offset:45056
    ds_read_b128 v[20:23], v81 offset:45568
    s_mov_b64 exec, -1
    ds_read_b128 v[12:15], v80 offset:47104
    v_exp_f32 v50, v50
    v_exp_f32 v51, v51
    v_exp_f32 v52, v52
    s_waitcnt lgkmcnt(3)
    v_mfma_f32_32x32x16_bf16 v[32:47], v[8:11], v[4:7], 0
    v_exp_f32 v53, v53
    v_exp_f32 v54, v54
    v_exp_f32 v55, v55
    v_exp_f32 v56, v56
    v_exp_f32 v57, v57
    v_smfmac_f32_32x32x32_bf16 v[64:79], v[24:27], v[48:55], v3
    v_exp_f32 v58, v58
    v_exp_f32 v59, v59
    v_exp_f32 v60, v60
    v_exp_f32 v61, v61
    v_exp_f32 v62, v62
    v_exp_f32 v63, v63
    s_setprio 2
    v_exp_f32 v32, v32
    v_exp_f32 v33, v33
    v_smfmac_f32_32x32x32_bf16 v[64:79], v[28:31], v[56:63], v3
    s_add_u32 m0, s79, 40960
    s_add_u32 s80, s78, 40960
    buffer_load_dwordx4 v1, s[40:43], s80 offen sc1 lds
    s_mov_b64 exec, s[82:83]
    ds_read_b128 v[24:27], v81 offset:47104
    ds_read_b128 v[28:31], v81 offset:47616
    s_mov_b64 exec, -1
    ds_read_b128 v[8:11], v80 offset:49152
    v_exp_f32 v34, v34
    v_exp_f32 v35, v35
    v_exp_f32 v36, v36
    s_waitcnt lgkmcnt(3)
    v_mfma_f32_32x32x16_bf16 v[48:63], v[12:15], v[4:7], 0
    v_exp_f32 v37, v37
    v_exp_f32 v38, v38
    v_exp_f32 v39, v39
    v_exp_f32 v40, v40
    v_exp_f32 v41, v41
    v_smfmac_f32_32x32x32_bf16 v[64:79], v[16:19], v[32:39], v3
    v_exp_f32 v42, v42
    v_exp_f32 v43, v43
    v_exp_f32 v44, v44
    v_exp_f32 v45, v45
    v_exp_f32 v46, v46
    v_exp_f32 v47, v47
    v_exp_f32 v48, v48
    v_exp_f32 v49, v49
    v_smfmac_f32_32x32x32_bf16 v[64:79], v[20:23], v[40:47], v3
    s_add_u32 m0, s79, 49152
    s_add_u32 s80, s78, 49152
    buffer_load_dwordx4 v1, s[40:43], s80 offen sc1 lds
    s_mov_b64 exec, s[82:83]
    ds_read_b128 v[16:19], v81 offset:49152
    ds_read_b128 v[20:23], v81 offset:49664
    s_mov_b64 exec, -1
    ds_read_b128 v[12:15], v80 offset:51200
    v_exp_f32 v50, v50
    v_exp_f32 v51, v51
    v_exp_f32 v52, v52
    s_waitcnt lgkmcnt(3)
    v_mfma_f32_32x32x16_bf16 v[32:47], v[8:11], v[4:7], 0
    v_exp_f32 v53, v53
    v_exp_f32 v54, v54
    v_exp_f32 v55, v55
    v_exp_f32 v56, v56
    v_exp_f32 v57, v57
    v_smfmac_f32_32x32x32_bf16 v[64:79], v[24:27], v[48:55], v3
    v_exp_f32 v58, v58
    v_exp_f32 v59, v59
    v_exp_f32 v60, v60
    v_exp_f32 v61, v61
    v_exp_f32 v62, v62
    v_exp_f32 v63, v63
    s_setprio 1
    v_exp_f32 v32, v32
    v_exp_f32 v33, v33
    v_smfmac_f32_32x32x32_bf16 v[64:79], v[28:31], v[56:63], v3
    s_add_u32 m0, s79, 57344
    s_add_u32 s80, s78, 57344
    buffer_load_dwordx4 v1, s[40:43], s80 offen sc1 lds
    s_mov_b64 exec, s[82:83]
    ds_read_b128 v[24:27], v81 offset:51200
    ds_read_b128 v[28:31], v81 offset:51712
    s_mov_b64 exec, -1
    ds_read_b128 v[8:11], v80 offset:53248
    v_exp_f32 v34, v34
    v_exp_f32 v35, v35
    v_exp_f32 v36, v36
    s_waitcnt lgkmcnt(3)
    v_mfma_f32_32x32x16_bf16 v[48:63], v[12:15], v[4:7], 0
    v_exp_f32 v37, v37
    v_exp_f32 v38, v38
    v_exp_f32 v39, v39
    v_exp_f32 v40, v40
    v_exp_f32 v41, v41
    v_smfmac_f32_32x32x32_bf16 v[64:79], v[16:19], v[32:39], v3
    v_exp_f32 v42, v42
    v_exp_f32 v43, v43
    v_exp_f32 v44, v44
    v_exp_f32 v45, v45
    v_exp_f32 v46, v46
    v_exp_f32 v47, v47
    s_setprio 0
    v_exp_f32 v48, v48
    v_exp_f32 v49, v49
    v_smfmac_f32_32x32x32_bf16 v[64:79], v[20:23], v[40:47], v3
    s_add_u32 m0, s79, 65536
    s_add_u32 s80, s78, 65536
    buffer_load_dwordx4 v1, s[40:43], s80 offen sc1 lds
    s_mov_b64 exec, s[82:83]
    ds_read_b128 v[16:19], v81 offset:53248
    ds_read_b128 v[20:23], v81 offset:53760
    s_mov_b64 exec, -1
    ds_read_b128 v[12:15], v80 offset:55296
    v_exp_f32 v50, v50
    v_exp_f32 v51, v51
    v_exp_f32 v52, v52
    s_waitcnt lgkmcnt(3)
    v_mfma_f32_32x32x16_bf16 v[32:47], v[8:11], v[4:7], 0
    v_exp_f32 v53, v53
    v_exp_f32 v54, v54
    v_exp_f32 v55, v55
    v_exp_f32 v56, v56
    v_exp_f32 v57, v57
    v_smfmac_f32_32x32x32_bf16 v[64:79], v[24:27], v[48:55], v3
    v_exp_f32 v58, v58
    v_exp_f32 v59, v59
    v_exp_f32 v60, v60
    v_exp_f32 v61, v61
    v_exp_f32 v62, v62
    v_exp_f32 v63, v63
    s_setprio 3
    v_exp_f32 v32, v32
    v_exp_f32 v33, v33
    v_smfmac_f32_32x32x32_bf16 v[64:79], v[28:31], v[56:63], v3
    s_waitcnt vmcnt(1)
    s_barrier
    s_add_u32 m0, s79, 73728
    s_add_u32 s80, s78, 73728
    buffer_load_dwordx4 v1, s[40:43], s80 offen sc1 lds
    s_mov_b64 exec, s[82:83]
    ds_read_b128 v[24:27], v81 offset:55296
    ds_read_b128 v[28:31], v81 offset:55808
    s_mov_b64 exec, -1
    ds_read_b128 v[8:11], v80 offset:57344
    v_exp_f32 v34, v34
    v_exp_f32 v35, v35
    v_exp_f32 v36, v36
    s_waitcnt lgkmcnt(3)
    v_mfma_f32_32x32x16_bf16 v[48:63], v[12:15], v[4:7], 0
    v_exp_f32 v37, v37
    v_exp_f32 v38, v38
    v_exp_f32 v39, v39
    v_exp_f32 v40, v40
    v_exp_f32 v41, v41
    v_smfmac_f32_32x32x32_bf16 v[64:79], v[16:19], v[32:39], v3
    v_exp_f32 v42, v42
    v_exp_f32 v43, v43
    v_exp_f32 v44, v44
    v_exp_f32 v45, v45
    v_exp_f32 v46, v46
    v_exp_f32 v47, v47
    v_exp_f32 v48, v48
    v_exp_f32 v49, v49
    v_smfmac_f32_32x32x32_bf16 v[64:79], v[20:23], v[40:47], v3
    s_add_u32 m0, s79, 81920
    s_add_u32 s80, s78, 81920
    buffer_load_dwordx4 v1, s[40:43], s80 offen sc1 lds
    s_mov_b64 exec, s[82:83]
    ds_read_b128 v[16:19], v81 offset:57344
    ds_read_b128 v[20:23], v81 offset:57856
    s_mov_b64 exec, -1
    ds_read_b128 v[12:15], v80 offset:59392
    v_exp_f32 v50, v50
    v_exp_f32 v51, v51
    v_exp_f32 v52, v52
    s_waitcnt lgkmcnt(3)
    v_mfma_f32_32x32x16_bf16 v[32:47], v[8:11], v[4:7], 0
    v_exp_f32 v53, v53
    v_exp_f32 v54, v54
    v_exp_f32 v55, v55
    v_exp_f32 v56, v56
    v_exp_f32 v57, v57
    v_smfmac_f32_32x32x32_bf16 v[64:79], v[24:27], v[48:55], v3
    v_exp_f32 v58, v58
    v_exp_f32 v59, v59
    v_exp_f32 v60, v60
    v_exp_f32 v61, v61
    v_exp_f32 v62, v62
    v_exp_f32 v63, v63
    v_exp_f32 v32, v32
    v_exp_f32 v33, v33
    v_smfmac_f32_32x32x32_bf16 v[64:79], v[28:31], v[56:63], v3
    s_add_u32 m0, s79, 90112
    s_add_u32 s80, s78, 90112
    buffer_load_dwordx4 v1, s[40:43], s80 offen sc1 lds
    s_mov_b64 exec, s[82:83]
    ds_read_b128 v[24:27], v81 offset:59392
    ds_read_b128 v[28:31], v81 offset:59904
    s_mov_b64 exec, -1
    ds_read_b128 v[8:11], v80 offset:61440
    v_exp_f32 v34, v34
    v_exp_f32 v35, v35
    v_exp_f32 v36, v36
    s_waitcnt lgkmcnt(3)
    v_mfma_f32_32x32x16_bf16 v[48:63], v[12:15], v[4:7], 0
    v_exp_f32 v37, v37
    v_exp_f32 v38, v38
    v_exp_f32 v39, v39
    v_exp_f32 v40, v40
    v_exp_f32 v41, v41
    v_smfmac_f32_32x32x32_bf16 v[64:79], v[16:19], v[32:39], v3
    v_exp_f32 v42, v42
    v_exp_f32 v43, v43
    v_exp_f32 v44, v44
    v_exp_f32 v45, v45
    v_exp_f32 v46, v46
    v_exp_f32 v47, v47
    v_exp_f32 v48, v48
    v_exp_f32 v49, v49
    v_smfmac_f32_32x32x32_bf16 v[64:79], v[20:23], v[40:47], v3
    s_mov_b64 exec, s[82:83]
    ds_read_b128 v[16:19], v81 offset:61440
    ds_read_b128 v[20:23], v81 offset:61952
    s_mov_b64 exec, -1
    ds_read_b128 v[12:15], v80 offset:63488
    v_exp_f32 v50, v50
    v_exp_f32 v51, v51
    v_exp_f32 v52, v52
    s_waitcnt lgkmcnt(3)
    v_mfma_f32_32x32x16_bf16 v[32:47], v[8:11], v[4:7], 0
    v_exp_f32 v53, v53
    v_exp_f32 v54, v54
    v_exp_f32 v55, v55
    v_exp_f32 v56, v56
    v_exp_f32 v57, v57
    v_smfmac_f32_32x32x32_bf16 v[64:79], v[24:27], v[48:55], v3
    v_exp_f32 v58, v58
    v_exp_f32 v59, v59
    v_exp_f32 v60, v60
    v_exp_f32 v61, v61
    v_exp_f32 v62, v62
    v_exp_f32 v63, v63
    v_exp_f32 v32, v32
    v_exp_f32 v33, v33
    v_smfmac_f32_32x32x32_bf16 v[64:79], v[28:31], v[56:63], v3
    s_cmp_lt_u32 s50, 4
    s_cbranch_scc1 L_df_g
    buffer_store_dwordx2 v[224:225], v232, s[40:43], s66 offen sc1
    buffer_store_dwordx2 v[226:227], v233, s[40:43], s66 offen sc1
    buffer_store_dwordx2 v[228:229], v234, s[40:43], s66 offen sc1
    buffer_store_dwordx2 v[230:231], v235, s[40:43], s66 offen sc1
    s_branch L_df_done
L_df_g:
    buffer_store_dwordx4 v[224:227], v1, s[40:43], s69 offen sc1
    s_mov_b32 exec_lo, 0
    s_mov_b32 exec_hi, 0x80000000
    buffer_store_dwordx2 v[228:229], v242, s[40:43], s67 offen sc1
    s_mov_b64 exec, -1
L_df_done:
    s_lshl_b32 s87, s76, 5
    s_add_u32 s87, s87, s74
    s_lshl_b32 s87, s87, 10
    s_add_u32 s87, s87, 10485760
    buffer_store_dwordx4 v[236:239], v1, s[40:43], s87 offen sc1
    s_mov_b64 exec, s[82:83]
    ds_read_b128 v[24:27], v81 offset:63488
    ds_read_b128 v[28:31], v81 offset:64000
    s_mov_b64 exec, -1
    ds_read_b128 v[8:11], v1 offset:0
    v_exp_f32 v34, v34
    v_exp_f32 v35, v35
    v_exp_f32 v36, v36
    s_waitcnt lgkmcnt(3)
    v_mfma_f32_32x32x16_bf16 v[48:63], v[12:15], v[4:7], 0
    v_exp_f32 v37, v37
    v_exp_f32 v38, v38
    v_exp_f32 v39, v39
    v_exp_f32 v40, v40
    v_exp_f32 v41, v41
    v_smfmac_f32_32x32x32_bf16 v[64:79], v[16:19], v[32:39], v3
    v_exp_f32 v42, v42
    v_exp_f32 v43, v43
    v_exp_f32 v44, v44
    v_exp_f32 v45, v45
    v_exp_f32 v46, v46
    v_exp_f32 v47, v47
    v_exp_f32 v48, v48
    v_exp_f32 v49, v49
    v_smfmac_f32_32x32x32_bf16 v[64:79], v[20:23], v[40:47], v3
    s_mov_b64 exec, s[82:83]
    ds_read_b128 v[16:19], v2 offset:0
    ds_read_b128 v[20:23], v2 offset:512
    s_mov_b64 exec, -1
    ds_read_b128 v[12:15], v1 offset:2048
    v_exp_f32 v50, v50
    v_exp_f32 v51, v51
    v_exp_f32 v52, v52
    s_waitcnt lgkmcnt(3)
    v_mfma_f32_32x32x16_bf16 v[32:47], v[8:11], v[4:7], 0
    v_exp_f32 v53, v53
    v_exp_f32 v54, v54
    v_exp_f32 v55, v55
    v_exp_f32 v56, v56
    v_exp_f32 v57, v57
    v_smfmac_f32_32x32x32_bf16 v[64:79], v[24:27], v[48:55], v3
    v_exp_f32 v58, v58
    v_exp_f32 v59, v59
    v_exp_f32 v60, v60
    v_exp_f32 v61, v61
    v_exp_f32 v62, v62
    v_exp_f32 v63, v63
    v_exp_f32 v32, v32
    v_exp_f32 v33, v33
    v_smfmac_f32_32x32x32_bf16 v[64:79], v[28:31], v[56:63], v3
    s_mov_b64 exec, s[82:83]
    ds_read_b128 v[24:27], v2 offset:2048
    ds_read_b128 v[28:31], v2 offset:2560
    s_mov_b64 exec, -1
    ds_read_b128 v[8:11], v1 offset:4096
    v_exp_f32 v34, v34
    v_exp_f32 v35, v35
    v_exp_f32 v36, v36
    s_waitcnt lgkmcnt(3)
    v_mfma_f32_32x32x16_bf16 v[48:63], v[12:15], v[4:7], 0
    v_exp_f32 v37, v37
    v_exp_f32 v38, v38
    v_exp_f32 v39, v39
    v_exp_f32 v40, v40
    v_exp_f32 v41, v41
    v_smfmac_f32_32x32x32_bf16 v[64:79], v[16:19], v[32:39], v3
    v_exp_f32 v42, v42
    v_exp_f32 v43, v43
    v_exp_f32 v44, v44
    v_exp_f32 v45, v45
    v_exp_f32 v46, v46
    v_exp_f32 v47, v47
    v_exp_f32 v48, v48
    v_exp_f32 v49, v49
    v_smfmac_f32_32x32x32_bf16 v[64:79], v[20:23], v[40:47], v3
    s_mov_b64 exec, s[82:83]
    ds_read_b128 v[16:19], v2 offset:4096
    ds_read_b128 v[20:23], v2 offset:4608
    s_mov_b64 exec, -1
    ds_read_b128 v[12:15], v1 offset:6144
    v_exp_f32 v50, v50
    v_exp_f32 v51, v51
    v_exp_f32 v52, v52
    s_waitcnt lgkmcnt(3)
    v_mfma_f32_32x32x16_bf16 v[32:47], v[8:11], v[4:7], 0
    v_exp_f32 v53, v53
    v_exp_f32 v54, v54
    v_exp_f32 v55, v55
    v_exp_f32 v56, v56
    v_exp_f32 v57, v57
    v_smfmac_f32_32x32x32_bf16 v[64:79], v[24:27], v[48:55], v3
    v_exp_f32 v58, v58
    v_exp_f32 v59, v59
    v_exp_f32 v60, v60
    v_exp_f32 v61, v61
    v_exp_f32 v62, v62
    v_exp_f32 v63, v63
    v_exp_f32 v32, v32
    v_exp_f32 v33, v33
    v_smfmac_f32_32x32x32_bf16 v[64:79], v[28:31], v[56:63], v3
    s_mov_b64 exec, s[82:83]
    ds_read_b128 v[24:27], v2 offset:6144
    ds_read_b128 v[28:31], v2 offset:6656
    s_mov_b64 exec, -1
    ds_read_b128 v[8:11], v1 offset:8192
    v_exp_f32 v34, v34
    v_exp_f32 v35, v35
    v_exp_f32 v36, v36
    s_waitcnt lgkmcnt(3)
    v_mfma_f32_32x32x16_bf16 v[48:63], v[12:15], v[4:7], 0
    v_exp_f32 v37, v37
    v_exp_f32 v38, v38
    v_exp_f32 v39, v39
    v_exp_f32 v40, v40
    v_exp_f32 v41, v41
    v_smfmac_f32_32x32x32_bf16 v[64:79], v[16:19], v[32:39], v3
    v_exp_f32 v42, v42
    v_exp_f32 v43, v43
    v_exp_f32 v44, v44
    v_exp_f32 v45, v45
    v_exp_f32 v46, v46
    v_exp_f32 v47, v47
    v_exp_f32 v48, v48
    v_exp_f32 v49, v49
    v_smfmac_f32_32x32x32_bf16 v[64:79], v[20:23], v[40:47], v3
    s_waitcnt vmcnt(0)
    s_mov_b64 exec, 1
    ds_add_rtn_u32 v93, v92, v93
    s_mov_b64 exec, -1
    s_mov_b64 exec, s[82:83]
    ds_read_b128 v[16:19], v2 offset:8192
    ds_read_b128 v[20:23], v2 offset:8704
    s_mov_b64 exec, -1
    ds_read_b128 v[12:15], v1 offset:10240
    v_exp_f32 v50, v50
    v_exp_f32 v51, v51
    v_exp_f32 v52, v52
    s_waitcnt lgkmcnt(3)
    v_mfma_f32_32x32x16_bf16 v[32:47], v[8:11], v[4:7], 0
    v_exp_f32 v53, v53
    v_exp_f32 v54, v54
    v_exp_f32 v55, v55
    v_exp_f32 v56, v56
    v_exp_f32 v57, v57
    v_smfmac_f32_32x32x32_bf16 v[64:79], v[24:27], v[48:55], v3
    v_exp_f32 v58, v58
    v_exp_f32 v59, v59
    v_exp_f32 v60, v60
    v_exp_f32 v61, v61
    v_exp_f32 v62, v62
    v_exp_f32 v63, v63
    v_exp_f32 v32, v32
    v_exp_f32 v33, v33
    v_smfmac_f32_32x32x32_bf16 v[64:79], v[28:31], v[56:63], v3
    v_readfirstlane_b32 s84, v93
    s_lshl_b32 s85, s49, 7
    s_lshl_b32 s86, s48, 2
    s_add_u32 s85, s85, s86
    s_add_u32 s85, s85, 13189120
    s_cmp_lg_u32 s84, 7
    s_cbranch_scc1 L_s3_skip
    s_mov_b64 exec, 1
    buffer_store_dword v240, v242, s[40:43], s85 offen sc1
    s_mov_b64 exec, -1
L_s3_skip:
    s_mov_b64 exec, s[82:83]
    ds_read_b128 v[24:27], v2 offset:10240
    ds_read_b128 v[28:31], v2 offset:10752
    s_mov_b64 exec, -1
    ds_read_b128 v[8:11], v1 offset:12288
    v_exp_f32 v34, v34
    v_exp_f32 v35, v35
    v_exp_f32 v36, v36
    s_waitcnt lgkmcnt(3)
    v_mfma_f32_32x32x16_bf16 v[48:63], v[12:15], v[4:7], 0
    v_exp_f32 v37, v37
    v_exp_f32 v38, v38
    v_exp_f32 v39, v39
    v_exp_f32 v40, v40
    v_exp_f32 v41, v41
    v_smfmac_f32_32x32x32_bf16 v[64:79], v[16:19], v[32:39], v3
    v_exp_f32 v42, v42
    v_exp_f32 v43, v43
    v_exp_f32 v44, v44
    v_exp_f32 v45, v45
    v_exp_f32 v46, v46
    v_exp_f32 v47, v47
    v_exp_f32 v48, v48
    v_exp_f32 v49, v49
    v_smfmac_f32_32x32x32_bf16 v[64:79], v[20:23], v[40:47], v3
    s_mov_b64 exec, s[82:83]
    ds_read_b128 v[16:19], v2 offset:12288
    ds_read_b128 v[20:23], v2 offset:12800
    s_mov_b64 exec, -1
    ds_read_b128 v[12:15], v1 offset:14336
    v_exp_f32 v50, v50
    v_exp_f32 v51, v51
    v_exp_f32 v52, v52
    s_waitcnt lgkmcnt(3)
    v_mfma_f32_32x32x16_bf16 v[32:47], v[8:11], v[4:7], 0
    v_exp_f32 v53, v53
    v_exp_f32 v54, v54
    v_exp_f32 v55, v55
    v_exp_f32 v56, v56
    v_exp_f32 v57, v57
    v_smfmac_f32_32x32x32_bf16 v[64:79], v[24:27], v[48:55], v3
    v_exp_f32 v58, v58
    v_exp_f32 v59, v59
    v_exp_f32 v60, v60
    v_exp_f32 v61, v61
    v_exp_f32 v62, v62
    v_exp_f32 v63, v63
    s_setprio 2
    v_exp_f32 v32, v32
    v_exp_f32 v33, v33
    v_smfmac_f32_32x32x32_bf16 v[64:79], v[28:31], v[56:63], v3
    s_mov_b64 exec, s[82:83]
    ds_read_b128 v[24:27], v2 offset:14336
    ds_read_b128 v[28:31], v2 offset:14848
    s_mov_b64 exec, -1
    ds_read_b128 v[8:11], v1 offset:16384
    v_exp_f32 v34, v34
    v_exp_f32 v35, v35
    v_exp_f32 v36, v36
    s_waitcnt lgkmcnt(3)
    v_mfma_f32_32x32x16_bf16 v[48:63], v[12:15], v[4:7], 0
    v_exp_f32 v37, v37
    v_exp_f32 v38, v38
    v_exp_f32 v39, v39
    v_exp_f32 v40, v40
    v_exp_f32 v41, v41
    v_smfmac_f32_32x32x32_bf16 v[64:79], v[16:19], v[32:39], v3
    v_exp_f32 v42, v42
    v_exp_f32 v43, v43
    v_exp_f32 v44, v44
    v_exp_f32 v45, v45
    v_exp_f32 v46, v46
    v_exp_f32 v47, v47
    v_exp_f32 v48, v48
    v_exp_f32 v49, v49
    v_smfmac_f32_32x32x32_bf16 v[64:79], v[20:23], v[40:47], v3
    s_mov_b64 exec, s[82:83]
    ds_read_b128 v[16:19], v2 offset:16384
    ds_read_b128 v[20:23], v2 offset:16896
    s_mov_b64 exec, -1
    ds_read_b128 v[12:15], v1 offset:18432
    v_exp_f32 v50, v50
    v_exp_f32 v51, v51
    v_exp_f32 v52, v52
    s_waitcnt lgkmcnt(3)
    v_mfma_f32_32x32x16_bf16 v[32:47], v[8:11], v[4:7], 0
    v_exp_f32 v53, v53
    v_exp_f32 v54, v54
    v_exp_f32 v55, v55
    v_exp_f32 v56, v56
    v_exp_f32 v57, v57
    v_smfmac_f32_32x32x32_bf16 v[64:79], v[24:27], v[48:55], v3
    v_exp_f32 v58, v58
    v_exp_f32 v59, v59
    v_exp_f32 v60, v60
    v_exp_f32 v61, v61
    v_exp_f32 v62, v62
    v_exp_f32 v63, v63
    v_exp_f32 v32, v32
    v_exp_f32 v33, v33
    v_smfmac_f32_32x32x32_bf16 v[64:79], v[28:31], v[56:63], v3
    s_or_b32 s84, s49, s50
    s_cmp_lg_u32 s84, 0
    s_cbranch_scc1 L_wb_skip
    buffer_wbl2 sc1
L_wb_skip:
    s_mov_b64 exec, s[82:83]
    ds_read_b128 v[24:27], v2 offset:18432
    ds_read_b128 v[28:31], v2 offset:18944
    s_mov_b64 exec, -1
    ds_read_b128 v[8:11], v1 offset:20480
    v_exp_f32 v34, v34
    v_exp_f32 v35, v35
    v_exp_f32 v36, v36
    s_waitcnt lgkmcnt(3)
    v_mfma_f32_32x32x16_bf16 v[48:63], v[12:15], v[4:7], 0
    v_exp_f32 v37, v37
    v_exp_f32 v38, v38
    v_exp_f32 v39, v39
    v_exp_f32 v40, v40
    v_exp_f32 v41, v41
    v_smfmac_f32_32x32x32_bf16 v[64:79], v[16:19], v[32:39], v3
    v_exp_f32 v42, v42
    v_exp_f32 v43, v43
    v_exp_f32 v44, v44
    v_exp_f32 v45, v45
    v_exp_f32 v46, v46
    v_exp_f32 v47, v47
    v_exp_f32 v48, v48
    v_exp_f32 v49, v49
    v_smfmac_f32_32x32x32_bf16 v[64:79], v[20:23], v[40:47], v3
    s_mov_b64 exec, s[82:83]
    ds_read_b128 v[16:19], v2 offset:20480
    ds_read_b128 v[20:23], v2 offset:20992
    s_mov_b64 exec, -1
    ds_read_b128 v[12:15], v1 offset:22528
    v_exp_f32 v50, v50
    v_exp_f32 v51, v51
    v_exp_f32 v52, v52
    s_waitcnt lgkmcnt(3)
    v_mfma_f32_32x32x16_bf16 v[32:47], v[8:11], v[4:7], 0
    v_exp_f32 v53, v53
    v_exp_f32 v54, v54
    v_exp_f32 v55, v55
    v_exp_f32 v56, v56
    v_exp_f32 v57, v57
    v_smfmac_f32_32x32x32_bf16 v[64:79], v[24:27], v[48:55], v3
    v_exp_f32 v58, v58
    v_exp_f32 v59, v59
    v_exp_f32 v60, v60
    v_exp_f32 v61, v61
    v_exp_f32 v62, v62
    v_exp_f32 v63, v63
    v_exp_f32 v32, v32
    v_exp_f32 v33, v33
    v_smfmac_f32_32x32x32_bf16 v[64:79], v[28:31], v[56:63], v3
    s_mov_b64 exec, s[82:83]
    ds_read_b128 v[24:27], v2 offset:22528
    ds_read_b128 v[28:31], v2 offset:23040
    s_mov_b64 exec, -1
    ds_read_b128 v[8:11], v1 offset:24576
    v_exp_f32 v34, v34
    v_exp_f32 v35, v35
    v_exp_f32 v36, v36
    s_waitcnt lgkmcnt(3)
    v_mfma_f32_32x32x16_bf16 v[48:63], v[12:15], v[4:7], 0
    v_exp_f32 v37, v37
    v_exp_f32 v38, v38
    v_exp_f32 v39, v39
    v_exp_f32 v40, v40
    v_exp_f32 v41, v41
    v_smfmac_f32_32x32x32_bf16 v[64:79], v[16:19], v[32:39], v3
    v_exp_f32 v42, v42
    v_exp_f32 v43, v43
    v_exp_f32 v44, v44
    v_exp_f32 v45, v45
    v_exp_f32 v46, v46
    v_exp_f32 v47, v47
    v_exp_f32 v48, v48
    v_exp_f32 v49, v49
    v_smfmac_f32_32x32x32_bf16 v[64:79], v[20:23], v[40:47], v3
    s_mov_b64 exec, s[82:83]
    ds_read_b128 v[16:19], v2 offset:24576
    ds_read_b128 v[20:23], v2 offset:25088
    s_mov_b64 exec, -1
    ds_read_b128 v[12:15], v1 offset:26624
    v_exp_f32 v50, v50
    v_exp_f32 v51, v51
    v_exp_f32 v52, v52
    s_waitcnt lgkmcnt(3)
    v_mfma_f32_32x32x16_bf16 v[32:47], v[8:11], v[4:7], 0
    v_exp_f32 v53, v53
    v_exp_f32 v54, v54
    v_exp_f32 v55, v55
    v_exp_f32 v56, v56
    v_exp_f32 v57, v57
    v_smfmac_f32_32x32x32_bf16 v[64:79], v[24:27], v[48:55], v3
    v_exp_f32 v58, v58
    v_exp_f32 v59, v59
    v_exp_f32 v60, v60
    v_exp_f32 v61, v61
    v_exp_f32 v62, v62
    v_exp_f32 v63, v63
    v_exp_f32 v32, v32
    v_exp_f32 v33, v33
    v_smfmac_f32_32x32x32_bf16 v[64:79], v[28:31], v[56:63], v3
    s_mov_b64 exec, s[82:83]
    ds_read_b128 v[24:27], v2 offset:26624
    ds_read_b128 v[28:31], v2 offset:27136
    s_mov_b64 exec, -1
    ds_read_b128 v[8:11], v1 offset:28672
    v_exp_f32 v34, v34
    v_exp_f32 v35, v35
    v_exp_f32 v36, v36
    s_waitcnt lgkmcnt(3)
    v_mfma_f32_32x32x16_bf16 v[48:63], v[12:15], v[4:7], 0
    v_exp_f32 v37, v37
    v_exp_f32 v38, v38
    v_exp_f32 v39, v39
    v_exp_f32 v40, v40
    v_exp_f32 v41, v41
    v_smfmac_f32_32x32x32_bf16 v[64:79], v[16:19], v[32:39], v3
    v_exp_f32 v42, v42
    v_exp_f32 v43, v43
    v_exp_f32 v44, v44
    v_exp_f32 v45, v45
    v_exp_f32 v46, v46
    v_exp_f32 v47, v47
    v_exp_f32 v48, v48
    v_exp_f32 v49, v49
    v_smfmac_f32_32x32x32_bf16 v[64:79], v[20:23], v[40:47], v3
    s_mov_b64 exec, s[82:83]
    ds_read_b128 v[16:19], v2 offset:28672
    ds_read_b128 v[20:23], v2 offset:29184
    s_mov_b64 exec, -1
    ds_read_b128 v[12:15], v1 offset:30720
    v_exp_f32 v50, v50
    v_exp_f32 v51, v51
    v_exp_f32 v52, v52
    s_waitcnt lgkmcnt(3)
    v_mfma_f32_32x32x16_bf16 v[32:47], v[8:11], v[4:7], 0
    v_exp_f32 v53, v53
    v_exp_f32 v54, v54
    v_exp_f32 v55, v55
    v_exp_f32 v56, v56
    v_exp_f32 v57, v57
    v_smfmac_f32_32x32x32_bf16 v[64:79], v[24:27], v[48:55], v3
    v_exp_f32 v58, v58
    v_exp_f32 v59, v59
    v_exp_f32 v60, v60
    v_exp_f32 v61, v61
    v_exp_f32 v62, v62
    v_exp_f32 v63, v63
    v_exp_f32 v32, v32
    v_exp_f32 v33, v33
    v_smfmac_f32_32x32x32_bf16 v[64:79], v[28:31], v[56:63], v3
    s_mov_b64 exec, s[82:83]
    ds_read_b128 v[24:27], v2 offset:30720
    ds_read_b128 v[28:31], v2 offset:31232
    s_mov_b64 exec, -1
    ds_read_b128 v[8:11], v1 offset:32768
    v_exp_f32 v34, v34
    v_exp_f32 v35, v35
    v_exp_f32 v36, v36
    s_waitcnt lgkmcnt(3)
    v_mfma_f32_32x32x16_bf16 v[48:63], v[12:15], v[4:7], 0
    v_exp_f32 v37, v37
    v_exp_f32 v38, v38
    v_exp_f32 v39, v39
    v_exp_f32 v40, v40
    v_exp_f32 v41, v41
    v_smfmac_f32_32x32x32_bf16 v[64:79], v[16:19], v[32:39], v3
    v_exp_f32 v42, v42
    v_exp_f32 v43, v43
    v_exp_f32 v44, v44
    v_exp_f32 v45, v45
    v_exp_f32 v46, v46
    v_exp_f32 v47, v47
    v_exp_f32 v48, v48
    v_exp_f32 v49, v49
    v_smfmac_f32_32x32x32_bf16 v[64:79], v[20:23], v[40:47], v3
    s_mov_b64 exec, s[82:83]
    ds_read_b128 v[16:19], v2 offset:32768
    ds_read_b128 v[20:23], v2 offset:33280
    s_mov_b64 exec, -1
    ds_read_b128 v[12:15], v1 offset:34816
    v_exp_f32 v50, v50
    v_exp_f32 v51, v51
    v_exp_f32 v52, v52
    s_waitcnt lgkmcnt(3)
    v_mfma_f32_32x32x16_bf16 v[32:47], v[8:11], v[4:7], 0
    v_exp_f32 v53, v53
    v_exp_f32 v54, v54
    v_exp_f32 v55, v55
    v_exp_f32 v56, v56
    v_exp_f32 v57, v57
    v_smfmac_f32_32x32x32_bf16 v[64:79], v[24:27], v[48:55], v3
    v_exp_f32 v58, v58
    v_exp_f32 v59, v59
    v_exp_f32 v60, v60
    v_exp_f32 v61, v61
    v_exp_f32 v62, v62
    v_exp_f32 v63, v63
    v_exp_f32 v32, v32
    v_exp_f32 v33, v33
    v_smfmac_f32_32x32x32_bf16 v[64:79], v[28:31], v[56:63], v3
    s_mov_b64 exec, s[82:83]
    ds_read_b128 v[24:27], v2 offset:34816
    ds_read_b128 v[28:31], v2 offset:35328
    s_mov_b64 exec, -1
    ds_read_b128 v[8:11], v1 offset:36864
    v_exp_f32 v34, v34
    v_exp_f32 v35, v35
    v_exp_f32 v36, v36
    s_waitcnt lgkmcnt(3)
    v_mfma_f32_32x32x16_bf16 v[48:63], v[12:15], v[4:7], 0
    v_exp_f32 v37, v37
    v_exp_f32 v38, v38
    v_exp_f32 v39, v39
    v_exp_f32 v40, v40
    v_exp_f32 v41, v41
    v_smfmac_f32_32x32x32_bf16 v[64:79], v[16:19], v[32:39], v3
    v_exp_f32 v42, v42
    v_exp_f32 v43, v43
    v_exp_f32 v44, v44
    v_exp_f32 v45, v45
    v_exp_f32 v46, v46
    v_exp_f32 v47, v47
    v_exp_f32 v48, v48
    v_exp_f32 v49, v49
    v_smfmac_f32_32x32x32_bf16 v[64:79], v[20:23], v[40:47], v3
    s_mov_b64 exec, s[82:83]
    ds_read_b128 v[16:19], v2 offset:36864
    ds_read_b128 v[20:23], v2 offset:37376
    s_mov_b64 exec, -1
    ds_read_b128 v[12:15], v1 offset:38912
    v_exp_f32 v50, v50
    v_exp_f32 v51, v51
    v_exp_f32 v52, v52
    s_waitcnt lgkmcnt(3)
    v_mfma_f32_32x32x16_bf16 v[32:47], v[8:11], v[4:7], 0
    v_exp_f32 v53, v53
    v_exp_f32 v54, v54
    v_exp_f32 v55, v55
    v_exp_f32 v56, v56
    v_exp_f32 v57, v57
    v_smfmac_f32_32x32x32_bf16 v[64:79], v[24:27], v[48:55], v3
    v_exp_f32 v58, v58
    v_exp_f32 v59, v59
    v_exp_f32 v60, v60
    v_exp_f32 v61, v61
    v_exp_f32 v62, v62
    v_exp_f32 v63, v63
    v_exp_f32 v32, v32
    v_exp_f32 v33, v33
    v_smfmac_f32_32x32x32_bf16 v[64:79], v[28:31], v[56:63], v3
    v_lshrrev_b32 v91, 1, v0
    v_lshlrev_b32 v91, 7, v91
    v_and_b32 v90, 1, v0
    v_lshl_add_u32 v91, v90, 4, v91
    s_mov_b32 s84, 13189120
    buffer_load_dwordx4 v[244:247], v91, s[40:43], s84 offen sc1
    s_mov_b64 exec, s[82:83]
    ds_read_b128 v[24:27], v2 offset:38912
    ds_read_b128 v[28:31], v2 offset:39424
    s_mov_b64 exec, -1
    ds_read_b128 v[8:11], v1 offset:40960
    v_exp_f32 v34, v34
    v_exp_f32 v35, v35
    v_exp_f32 v36, v36
    s_waitcnt lgkmcnt(3)
    v_mfma_f32_32x32x16_bf16 v[48:63], v[12:15], v[4:7], 0
    v_exp_f32 v37, v37
    v_exp_f32 v38, v38
    v_exp_f32 v39, v39
    v_exp_f32 v40, v40
    v_exp_f32 v41, v41
    v_smfmac_f32_32x32x32_bf16 v[64:79], v[16:19], v[32:39], v3
    v_exp_f32 v42, v42
    v_exp_f32 v43, v43
    v_exp_f32 v44, v44
    v_exp_f32 v45, v45
    v_exp_f32 v46, v46
    v_exp_f32 v47, v47
    v_exp_f32 v48, v48
    v_exp_f32 v49, v49
    v_smfmac_f32_32x32x32_bf16 v[64:79], v[20:23], v[40:47], v3
    s_mov_b64 exec, s[82:83]
    ds_read_b128 v[16:19], v2 offset:40960
    ds_read_b128 v[20:23], v2 offset:41472
    s_mov_b64 exec, -1
    ds_read_b128 v[12:15], v1 offset:43008
    v_exp_f32 v50, v50
    v_exp_f32 v51, v51
    v_exp_f32 v52, v52
    s_waitcnt lgkmcnt(3)
    v_mfma_f32_32x32x16_bf16 v[32:47], v[8:11], v[4:7], 0
    v_exp_f32 v53, v53
    v_exp_f32 v54, v54
    v_exp_f32 v55, v55
    v_exp_f32 v56, v56
    v_exp_f32 v57, v57
    v_smfmac_f32_32x32x32_bf16 v[64:79], v[24:27], v[48:55], v3
    v_exp_f32 v58, v58
    v_exp_f32 v59, v59
    v_exp_f32 v60, v60
    v_exp_f32 v61, v61
    v_exp_f32 v62, v62
    v_exp_f32 v63, v63
    v_exp_f32 v32, v32
    v_exp_f32 v33, v33
    v_smfmac_f32_32x32x32_bf16 v[64:79], v[28:31], v[56:63], v3
    s_mov_b64 exec, s[82:83]
    ds_read_b128 v[24:27], v2 offset:43008
    ds_read_b128 v[28:31], v2 offset:43520
    s_mov_b64 exec, -1
    ds_read_b128 v[8:11], v1 offset:45056
    v_exp_f32 v34, v34
    v_exp_f32 v35, v35
    v_exp_f32 v36, v36
    s_waitcnt lgkmcnt(3)
    v_mfma_f32_32x32x16_bf16 v[48:63], v[12:15], v[4:7], 0
    v_exp_f32 v37, v37
    v_exp_f32 v38, v38
    v_exp_f32 v39, v39
    v_exp_f32 v40, v40
    v_exp_f32 v41, v41
    v_smfmac_f32_32x32x32_bf16 v[64:79], v[16:19], v[32:39], v3
    v_exp_f32 v42, v42
    v_exp_f32 v43, v43
    v_exp_f32 v44, v44
    v_exp_f32 v45, v45
    v_exp_f32 v46, v46
    v_exp_f32 v47, v47
    v_exp_f32 v48, v48
    v_exp_f32 v49, v49
    v_smfmac_f32_32x32x32_bf16 v[64:79], v[20:23], v[40:47], v3
    s_mov_b64 exec, s[82:83]
    ds_read_b128 v[16:19], v2 offset:45056
    ds_read_b128 v[20:23], v2 offset:45568
    s_mov_b64 exec, -1
    ds_read_b128 v[12:15], v1 offset:47104
    v_exp_f32 v50, v50
    v_exp_f32 v51, v51
    v_exp_f32 v52, v52
    s_waitcnt lgkmcnt(3)
    v_mfma_f32_32x32x16_bf16 v[32:47], v[8:11], v[4:7], 0
    v_exp_f32 v53, v53
    v_exp_f32 v54, v54
    v_exp_f32 v55, v55
    v_exp_f32 v56, v56
    v_exp_f32 v57, v57
    v_smfmac_f32_32x32x32_bf16 v[64:79], v[24:27], v[48:55], v3
    v_exp_f32 v58, v58
    v_exp_f32 v59, v59
    v_exp_f32 v60, v60
    v_exp_f32 v61, v61
    v_exp_f32 v62, v62
    v_exp_f32 v63, v63
    v_exp_f32 v32, v32
    v_exp_f32 v33, v33
    v_smfmac_f32_32x32x32_bf16 v[64:79], v[28:31], v[56:63], v3
    s_waitcnt vmcnt(0)
    s_mov_b32 s92, 400000
    s_branch L_s3_chk
L_s3_poll:
    buffer_load_dwordx4 v[244:247], v91, s[40:43], s84 offen sc1
    s_waitcnt vmcnt(0)
L_s3_chk:
    v_cmp_ne_u32 vcc, v244, v240
    v_cmp_ne_u32 s[90:91], v245, v240
    s_nop 1
    s_or_b64 vcc, vcc, s[90:91]
    v_cmp_ne_u32 s[90:91], v246, v240
    s_nop 1
    s_or_b64 vcc, vcc, s[90:91]
    v_cmp_ne_u32 s[90:91], v247, v240
    s_nop 1
    s_or_b64 vcc, vcc, s[90:91]
    s_cbranch_vccz L_s3_ok
    s_sleep 16
    s_sub_u32 s92, s92, 1
    s_cmp_lg_u32 s92, 0
    s_cbranch_scc1 L_s3_poll
L_s3_ok:
    s_lshl_b32 s88, s75, 3
    s_lshr_b32 s89, s74, 2
    s_add_u32 s88, s88, s89
    s_and_b32 s89, s74, 3
    s_lshl_b32 s89, s89, 3
    s_add_u32 s89, s89, s50
    s_lshl_b32 s90, s89, 14
    s_add_u32 s90, s90, 12582912
    s_lshl_b32 s86, s50, 12
    s_add_u32 s86, s86, 131072
    s_mov_b32 m0, s86
    v_add_u32 v92, s86, v1
    buffer_load_dwordx4 v1, s[40:43], s90 offen offset:0 sc1 lds
    buffer_load_dwordx4 v1, s[40:43], s90 offen offset:1024 sc1 lds
    buffer_load_dwordx4 v1, s[40:43], s90 offen offset:2048 sc1 lds
    buffer_load_dwordx4 v1, s[40:43], s90 offen offset:3072 sc1 lds
    s_add_u32 s90, s90, 4096
    s_or_b32 s84, s2, s50
    s_cmp_lg_u32 s84, 0
    s_cbranch_scc1 L_n_skip
    s_mov_b32 s84, 13172736
    s_mov_b64 exec, 1
    buffer_store_dword v240, v242, s[40:43], s84 offen sc1
    s_mov_b64 exec, -1
L_n_skip:
    s_mov_b64 exec, s[82:83]
    ds_read_b128 v[24:27], v2 offset:47104
    ds_read_b128 v[28:31], v2 offset:47616
    s_mov_b64 exec, -1
    ds_read_b128 v[8:11], v1 offset:49152
    v_exp_f32 v34, v34
    v_exp_f32 v35, v35
    v_exp_f32 v36, v36
    s_waitcnt lgkmcnt(3)
    v_mfma_f32_32x32x16_bf16 v[48:63], v[12:15], v[4:7], 0
    v_exp_f32 v37, v37
    v_exp_f32 v38, v38
    v_exp_f32 v39, v39
    v_exp_f32 v40, v40
    v_exp_f32 v41, v41
    v_smfmac_f32_32x32x32_bf16 v[64:79], v[16:19], v[32:39], v3
    v_exp_f32 v42, v42
    v_exp_f32 v43, v43
    v_exp_f32 v44, v44
    v_exp_f32 v45, v45
    v_exp_f32 v46, v46
    v_exp_f32 v47, v47
    v_exp_f32 v48, v48
    v_exp_f32 v49, v49
    v_smfmac_f32_32x32x32_bf16 v[64:79], v[20:23], v[40:47], v3
    s_mov_b64 exec, s[82:83]
    ds_read_b128 v[16:19], v2 offset:49152
    ds_read_b128 v[20:23], v2 offset:49664
    s_mov_b64 exec, -1
    ds_read_b128 v[12:15], v1 offset:51200
    v_exp_f32 v50, v50
    v_exp_f32 v51, v51
    v_exp_f32 v52, v52
    s_waitcnt lgkmcnt(3)
    v_mfma_f32_32x32x16_bf16 v[32:47], v[8:11], v[4:7], 0
    v_exp_f32 v53, v53
    v_exp_f32 v54, v54
    v_exp_f32 v55, v55
    v_exp_f32 v56, v56
    v_exp_f32 v57, v57
    v_smfmac_f32_32x32x32_bf16 v[64:79], v[24:27], v[48:55], v3
    v_exp_f32 v58, v58
    v_exp_f32 v59, v59
    v_exp_f32 v60, v60
    v_exp_f32 v61, v61
    v_exp_f32 v62, v62
    v_exp_f32 v63, v63
    v_exp_f32 v32, v32
    v_exp_f32 v33, v33
    v_smfmac_f32_32x32x32_bf16 v[64:79], v[28:31], v[56:63], v3
    s_mov_b64 exec, s[82:83]
    ds_read_b128 v[24:27], v2 offset:51200
    ds_read_b128 v[28:31], v2 offset:51712
    s_mov_b64 exec, -1
    ds_read_b128 v[8:11], v1 offset:53248
    v_exp_f32 v34, v34
    v_exp_f32 v35, v35
    v_exp_f32 v36, v36
    s_waitcnt lgkmcnt(3)
    v_mfma_f32_32x32x16_bf16 v[48:63], v[12:15], v[4:7], 0
    v_exp_f32 v37, v37
    v_exp_f32 v38, v38
    v_exp_f32 v39, v39
    v_exp_f32 v40, v40
    v_exp_f32 v41, v41
    v_smfmac_f32_32x32x32_bf16 v[64:79], v[16:19], v[32:39], v3
    v_exp_f32 v42, v42
    v_exp_f32 v43, v43
    v_exp_f32 v44, v44
    v_exp_f32 v45, v45
    v_exp_f32 v46, v46
    v_exp_f32 v47, v47
    v_exp_f32 v48, v48
    v_exp_f32 v49, v49
    v_smfmac_f32_32x32x32_bf16 v[64:79], v[20:23], v[40:47], v3
    s_mov_b64 exec, s[82:83]
    ds_read_b128 v[16:19], v2 offset:53248
    ds_read_b128 v[20:23], v2 offset:53760
    s_mov_b64 exec, -1
    ds_read_b128 v[12:15], v1 offset:55296
    v_exp_f32 v50, v50
    v_exp_f32 v51, v51
    v_exp_f32 v52, v52
    s_waitcnt lgkmcnt(3)
    v_mfma_f32_32x32x16_bf16 v[32:47], v[8:11], v[4:7], 0
    v_exp_f32 v53, v53
    v_exp_f32 v54, v54
    v_exp_f32 v55, v55
    v_exp_f32 v56, v56
    v_exp_f32 v57, v57
    v_smfmac_f32_32x32x32_bf16 v[64:79], v[24:27], v[48:55], v3
    v_exp_f32 v58, v58
    v_exp_f32 v59, v59
    v_exp_f32 v60, v60
    v_exp_f32 v61, v61
    v_exp_f32 v62, v62
    v_exp_f32 v63, v63
    v_exp_f32 v32, v32
    v_exp_f32 v33, v33
    v_smfmac_f32_32x32x32_bf16 v[64:79], v[28:31], v[56:63], v3
    s_waitcnt vmcnt(0)
    ds_read_b128 v[96:99], v92 offset:0
    ds_read_b128 v[100:103], v92 offset:1024
    ds_read_b128 v[104:107], v92 offset:2048
    ds_read_b128 v[108:111], v92 offset:3072
    s_mov_b64 exec, s[82:83]
    ds_read_b128 v[24:27], v2 offset:55296
    ds_read_b128 v[28:31], v2 offset:55808
    s_mov_b64 exec, -1
    ds_read_b128 v[8:11], v1 offset:57344
    v_exp_f32 v34, v34
    v_exp_f32 v35, v35
    v_exp_f32 v36, v36
    s_waitcnt lgkmcnt(3)
    v_mfma_f32_32x32x16_bf16 v[48:63], v[12:15], v[4:7], 0
    v_exp_f32 v37, v37
    v_exp_f32 v38, v38
    v_exp_f32 v39, v39
    v_exp_f32 v40, v40
    v_exp_f32 v41, v41
    v_smfmac_f32_32x32x32_bf16 v[64:79], v[16:19], v[32:39], v3
    v_exp_f32 v42, v42
    v_exp_f32 v43, v43
    v_exp_f32 v44, v44
    v_exp_f32 v45, v45
    v_exp_f32 v46, v46
    v_exp_f32 v47, v47
    v_exp_f32 v48, v48
    v_exp_f32 v49, v49
    v_smfmac_f32_32x32x32_bf16 v[64:79], v[20:23], v[40:47], v3
    buffer_load_dwordx4 v1, s[40:43], s90 offen offset:0 sc1 lds
    buffer_load_dwordx4 v1, s[40:43], s90 offen offset:1024 sc1 lds
    buffer_load_dwordx4 v1, s[40:43], s90 offen offset:2048 sc1 lds
    buffer_load_dwordx4 v1, s[40:43], s90 offen offset:3072 sc1 lds
    s_add_u32 s90, s90, 4096
    s_mov_b64 exec, s[82:83]
    ds_read_b128 v[16:19], v2 offset:57344
    ds_read_b128 v[20:23], v2 offset:57856
    s_mov_b64 exec, -1
    ds_read_b128 v[12:15], v1 offset:59392
    v_exp_f32 v50, v50
    v_exp_f32 v51, v51
    v_exp_f32 v52, v52
    s_waitcnt lgkmcnt(3)
    v_mfma_f32_32x32x16_bf16 v[32:47], v[8:11], v[4:7], 0
    v_exp_f32 v53, v53
    v_exp_f32 v54, v54
    v_exp_f32 v55, v55
    v_exp_f32 v56, v56
    v_exp_f32 v57, v57
    v_smfmac_f32_32x32x32_bf16 v[64:79], v[24:27], v[48:55], v3
    v_exp_f32 v58, v58
    v_exp_f32 v59, v59
    v_exp_f32 v60, v60
    v_exp_f32 v61, v61
    v_exp_f32 v62, v62
    v_exp_f32 v63, v63
    v_exp_f32 v32, v32
    v_exp_f32 v33, v33
    v_smfmac_f32_32x32x32_bf16 v[64:79], v[28:31], v[56:63], v3
    s_mov_b64 exec, s[82:83]
    ds_read_b128 v[24:27], v2 offset:59392
    ds_read_b128 v[28:31], v2 offset:59904
    s_mov_b64 exec, -1
    ds_read_b128 v[8:11], v1 offset:61440
    v_exp_f32 v34, v34
    v_exp_f32 v35, v35
    v_exp_f32 v36, v36
    s_waitcnt lgkmcnt(3)
    v_mfma_f32_32x32x16_bf16 v[48:63], v[12:15], v[4:7], 0
    v_exp_f32 v37, v37
    v_exp_f32 v38, v38
    v_exp_f32 v39, v39
    v_exp_f32 v40, v40
    v_exp_f32 v41, v41
    v_smfmac_f32_32x32x32_bf16 v[64:79], v[16:19], v[32:39], v3
    v_exp_f32 v42, v42
    v_exp_f32 v43, v43
    v_exp_f32 v44, v44
    v_exp_f32 v45, v45
    v_exp_f32 v46, v46
    v_exp_f32 v47, v47
    v_exp_f32 v48, v48
    v_exp_f32 v49, v49
    v_smfmac_f32_32x32x32_bf16 v[64:79], v[20:23], v[40:47], v3
    s_mov_b64 exec, s[82:83]
    ds_read_b128 v[16:19], v2 offset:61440
    ds_read_b128 v[20:23], v2 offset:61952
    s_mov_b64 exec, -1
    ds_read_b128 v[12:15], v1 offset:63488
    v_exp_f32 v50, v50
    v_exp_f32 v51, v51
    v_exp_f32 v52, v52
    s_waitcnt lgkmcnt(3)
    v_mfma_f32_32x32x16_bf16 v[32:47], v[8:11], v[4:7], 0
    v_exp_f32 v53, v53
    v_exp_f32 v54, v54
    v_exp_f32 v55, v55
    v_exp_f32 v56, v56
    v_exp_f32 v57, v57
    v_smfmac_f32_32x32x32_bf16 v[64:79], v[24:27], v[48:55], v3
    v_exp_f32 v58, v58
    v_exp_f32 v59, v59
    v_exp_f32 v60, v60
    v_exp_f32 v61, v61
    v_exp_f32 v62, v62
    v_exp_f32 v63, v63
    v_exp_f32 v32, v32
    v_exp_f32 v33, v33
    v_smfmac_f32_32x32x32_bf16 v[64:79], v[28:31], v[56:63], v3
    s_mov_b64 exec, s[82:83]
    ds_read_b128 v[24:27], v2 offset:63488
    ds_read_b128 v[28:31], v2 offset:64000
    s_mov_b64 exec, -1
    ds_read_b128 v[8:11], v80 offset:0
    v_exp_f32 v34, v34
    v_exp_f32 v35, v35
    v_exp_f32 v36, v36
    s_waitcnt lgkmcnt(3)
    v_mfma_f32_32x32x16_bf16 v[48:63], v[12:15], v[4:7], 0
    v_exp_f32 v37, v37
    v_exp_f32 v38, v38
    v_exp_f32 v39, v39
    v_exp_f32 v40, v40
    v_exp_f32 v41, v41
    v_smfmac_f32_32x32x32_bf16 v[64:79], v[16:19], v[32:39], v3
    v_exp_f32 v42, v42
    v_exp_f32 v43, v43
    v_exp_f32 v44, v44
    v_exp_f32 v45, v45
    v_exp_f32 v46, v46
    v_exp_f32 v47, v47
    v_exp_f32 v48, v48
    v_exp_f32 v49, v49
    v_smfmac_f32_32x32x32_bf16 v[64:79], v[20:23], v[40:47], v3
    s_waitcnt vmcnt(0)
    ds_read_b128 v[112:115], v92 offset:0
    ds_read_b128 v[116:119], v92 offset:1024
    ds_read_b128 v[120:123], v92 offset:2048
    ds_read_b128 v[124:127], v92 offset:3072
    s_mov_b64 exec, s[82:83]
    ds_read_b128 v[16:19], v81 offset:0
    ds_read_b128 v[20:23], v81 offset:512
    s_mov_b64 exec, -1
    ds_read_b128 v[12:15], v80 offset:2048
    v_exp_f32 v50, v50
    v_exp_f32 v51, v51
    v_exp_f32 v52, v52
    s_waitcnt lgkmcnt(3)
    v_mfma_f32_32x32x16_bf16 v[32:47], v[8:11], v[4:7], 0
    v_exp_f32 v53, v53
    v_exp_f32 v54, v54
    v_exp_f32 v55, v55
    v_exp_f32 v56, v56
    v_exp_f32 v57, v57
    v_smfmac_f32_32x32x32_bf16 v[64:79], v[24:27], v[48:55], v3
    v_exp_f32 v58, v58
    v_exp_f32 v59, v59
    v_exp_f32 v60, v60
    v_exp_f32 v61, v61
    v_exp_f32 v62, v62
    v_exp_f32 v63, v63
    s_setprio 1
    v_exp_f32 v32, v32
    v_exp_f32 v33, v33
    v_smfmac_f32_32x32x32_bf16 v[64:79], v[28:31], v[56:63], v3
    buffer_load_dwordx4 v1, s[40:43], s90 offen offset:0 sc1 lds
    buffer_load_dwordx4 v1, s[40:43], s90 offen offset:1024 sc1 lds
    buffer_load_dwordx4 v1, s[40:43], s90 offen offset:2048 sc1 lds
    buffer_load_dwordx4 v1, s[40:43], s90 offen offset:3072 sc1 lds
    s_add_u32 s90, s90, 4096
    s_mov_b64 exec, s[82:83]
    ds_read_b128 v[24:27], v81 offset:2048
    ds_read_b128 v[28:31], v81 offset:2560
    s_mov_b64 exec, -1
    ds_read_b128 v[8:11], v80 offset:4096
    v_exp_f32 v34, v34
    v_exp_f32 v35, v35
    v_exp_f32 v36, v36
    s_waitcnt lgkmcnt(3)
    v_mfma_f32_32x32x16_bf16 v[48:63], v[12:15], v[4:7], 0
    v_exp_f32 v37, v37
    v_exp_f32 v38, v38
    v_exp_f32 v39, v39
    v_exp_f32 v40, v40
    v_exp_f32 v41, v41
    v_smfmac_f32_32x32x32_bf16 v[64:79], v[16:19], v[32:39], v3
    v_exp_f32 v42, v42
    v_exp_f32 v43, v43
    v_exp_f32 v44, v44
    v_exp_f32 v45, v45
    v_exp_f32 v46, v46
    v_exp_f32 v47, v47
    v_exp_f32 v48, v48
    v_exp_f32 v49, v49
    v_smfmac_f32_32x32x32_bf16 v[64:79], v[20:23], v[40:47], v3
    s_mov_b64 exec, s[82:83]
    ds_read_b128 v[16:19], v81 offset:4096
    ds_read_b128 v[20:23], v81 offset:4608
    s_mov_b64 exec, -1
    ds_read_b128 v[12:15], v80 offset:6144
    v_exp_f32 v50, v50
    v_exp_f32 v51, v51
    v_exp_f32 v52, v52
    s_waitcnt lgkmcnt(3)
    v_mfma_f32_32x32x16_bf16 v[32:47], v[8:11], v[4:7], 0
    v_exp_f32 v53, v53
    v_exp_f32 v54, v54
    v_exp_f32 v55, v55
    v_exp_f32 v56, v56
    v_exp_f32 v57, v57
    v_smfmac_f32_32x32x32_bf16 v[64:79], v[24:27], v[48:55], v3
    v_exp_f32 v58, v58
    v_exp_f32 v59, v59
    v_exp_f32 v60, v60
    v_exp_f32 v61, v61
    v_exp_f32 v62, v62
    v_exp_f32 v63, v63
    v_exp_f32 v32, v32
    v_exp_f32 v33, v33
    v_smfmac_f32_32x32x32_bf16 v[64:79], v[28:31], v[56:63], v3
    s_mov_b64 exec, s[82:83]
    ds_read_b128 v[24:27], v81 offset:6144
    ds_read_b128 v[28:31], v81 offset:6656
    s_mov_b64 exec, -1
    ds_read_b128 v[8:11], v80 offset:8192
    v_exp_f32 v34, v34
    v_exp_f32 v35, v35
    v_exp_f32 v36, v36
    s_waitcnt lgkmcnt(3)
    v_mfma_f32_32x32x16_bf16 v[48:63], v[12:15], v[4:7], 0
    v_exp_f32 v37, v37
    v_exp_f32 v38, v38
    v_exp_f32 v39, v39
    v_exp_f32 v40, v40
    v_exp_f32 v41, v41
    v_smfmac_f32_32x32x32_bf16 v[64:79], v[16:19], v[32:39], v3
    v_exp_f32 v42, v42
    v_exp_f32 v43, v43
    v_exp_f32 v44, v44
    v_exp_f32 v45, v45
    v_exp_f32 v46, v46
    v_exp_f32 v47, v47
    v_exp_f32 v48, v48
    v_exp_f32 v49, v49
    v_smfmac_f32_32x32x32_bf16 v[64:79], v[20:23], v[40:47], v3
    s_mov_b64 exec, s[82:83]
    ds_read_b128 v[16:19], v81 offset:8192
    ds_read_b128 v[20:23], v81 offset:8704
    s_mov_b64 exec, -1
    ds_read_b128 v[12:15], v80 offset:10240
    v_exp_f32 v50, v50
    v_exp_f32 v51, v51
    v_exp_f32 v52, v52
    s_waitcnt lgkmcnt(3)
    v_mfma_f32_32x32x16_bf16 v[32:47], v[8:11], v[4:7], 0
    v_exp_f32 v53, v53
    v_exp_f32 v54, v54
    v_exp_f32 v55, v55
    v_exp_f32 v56, v56
    v_exp_f32 v57, v57
    v_smfmac_f32_32x32x32_bf16 v[64:79], v[24:27], v[48:55], v3
    v_exp_f32 v58, v58
    v_exp_f32 v59, v59
    v_exp_f32 v60, v60
    v_exp_f32 v61, v61
    v_exp_f32 v62, v62
    v_exp_f32 v63, v63
    v_exp_f32 v32, v32
    v_exp_f32 v33, v33
    v_smfmac_f32_32x32x32_bf16 v[64:79], v[28:31], v[56:63], v3
    s_waitcnt vmcnt(0)
    ds_read_b128 v[128:131], v92 offset:0
    ds_read_b128 v[132:135], v92 offset:1024
    ds_read_b128 v[136:139], v92 offset:2048
    ds_read_b128 v[140:143], v92 offset:3072
    s_mov_b64 exec, s[82:83]
    ds_read_b128 v[24:27], v81 offset:10240
    ds_read_b128 v[28:31], v81 offset:10752
    s_mov_b64 exec, -1
    ds_read_b128 v[8:11], v80 offset:12288
    v_exp_f32 v34, v34
    v_exp_f32 v35, v35
    v_exp_f32 v36, v36
    s_waitcnt lgkmcnt(3)
    v_mfma_f32_32x32x16_bf16 v[48:63], v[12:15], v[4:7], 0
    v_exp_f32 v37, v37
    v_exp_f32 v38, v38
    v_exp_f32 v39, v39
    v_exp_f32 v40, v40
    v_exp_f32 v41, v41
    v_smfmac_f32_32x32x32_bf16 v[64:79], v[16:19], v[32:39], v3
    v_exp_f32 v42, v42
    v_exp_f32 v43, v43
    v_exp_f32 v44, v44
    v_exp_f32 v45, v45
    v_exp_f32 v46, v46
    v_exp_f32 v47, v47
    v_exp_f32 v48, v48
    v_exp_f32 v49, v49
    v_smfmac_f32_32x32x32_bf16 v[64:79], v[20:23], v[40:47], v3
    buffer_load_dwordx4 v1, s[40:43], s90 offen offset:0 sc1 lds
    buffer_load_dwordx4 v1, s[40:43], s90 offen offset:1024 sc1 lds
    buffer_load_dwordx4 v1, s[40:43], s90 offen offset:2048 sc1 lds
    buffer_load_dwordx4 v1, s[40:43], s90 offen offset:3072 sc1 lds
    s_mov_b64 exec, s[82:83]
    ds_read_b128 v[16:19], v81 offset:12288
    ds_read_b128 v[20:23], v81 offset:12800
    s_mov_b64 exec, -1
    ds_read_b128 v[12:15], v80 offset:14336
    v_exp_f32 v50, v50
    v_exp_f32 v51, v51
    v_exp_f32 v52, v52
    s_waitcnt lgkmcnt(3)
    v_mfma_f32_32x32x16_bf16 v[32:47], v[8:11], v[4:7], 0
    v_exp_f32 v53, v53
    v_exp_f32 v54, v54
    v_exp_f32 v55, v55
    v_exp_f32 v56, v56
    v_exp_f32 v57, v57
    v_smfmac_f32_32x32x32_bf16 v[64:79], v[24:27], v[48:55], v3
    v_exp_f32 v58, v58
    v_exp_f32 v59, v59
    v_exp_f32 v60, v60
    v_exp_f32 v61, v61
    v_exp_f32 v62, v62
    v_exp_f32 v63, v63
    v_exp_f32 v32, v32
    v_exp_f32 v33, v33
    v_smfmac_f32_32x32x32_bf16 v[64:79], v[28:31], v[56:63], v3
    s_mov_b64 exec, s[82:83]
    ds_read_b128 v[24:27], v81 offset:14336
    ds_read_b128 v[28:31], v81 offset:14848
    s_mov_b64 exec, -1
    ds_read_b128 v[8:11], v80 offset:16384
    v_exp_f32 v34, v34
    v_exp_f32 v35, v35
    v_exp_f32 v36, v36
    s_waitcnt lgkmcnt(3)
    v_mfma_f32_32x32x16_bf16 v[48:63], v[12:15], v[4:7], 0
    v_exp_f32 v37, v37
    v_exp_f32 v38, v38
    v_exp_f32 v39, v39
    v_exp_f32 v40, v40
    v_exp_f32 v41, v41
    v_smfmac_f32_32x32x32_bf16 v[64:79], v[16:19], v[32:39], v3
    v_exp_f32 v42, v42
    v_exp_f32 v43, v43
    v_exp_f32 v44, v44
    v_exp_f32 v45, v45
    v_exp_f32 v46, v46
    v_exp_f32 v47, v47
    v_exp_f32 v48, v48
    v_exp_f32 v49, v49
    v_smfmac_f32_32x32x32_bf16 v[64:79], v[20:23], v[40:47], v3
    s_mov_b64 exec, s[82:83]
    ds_read_b128 v[16:19], v81 offset:16384
    ds_read_b128 v[20:23], v81 offset:16896
    s_mov_b64 exec, -1
    ds_read_b128 v[12:15], v80 offset:18432
    v_exp_f32 v50, v50
    v_exp_f32 v51, v51
    v_exp_f32 v52, v52
    s_waitcnt lgkmcnt(3)
    v_mfma_f32_32x32x16_bf16 v[32:47], v[8:11], v[4:7], 0
    v_exp_f32 v53, v53
    v_exp_f32 v54, v54
    v_exp_f32 v55, v55
    v_exp_f32 v56, v56
    v_exp_f32 v57, v57
    v_smfmac_f32_32x32x32_bf16 v[64:79], v[24:27], v[48:55], v3
    v_exp_f32 v58, v58
    v_exp_f32 v59, v59
    v_exp_f32 v60, v60
    v_exp_f32 v61, v61
    v_exp_f32 v62, v62
    v_exp_f32 v63, v63
    v_exp_f32 v32, v32
    v_exp_f32 v33, v33
    v_smfmac_f32_32x32x32_bf16 v[64:79], v[28:31], v[56:63], v3
    s_mov_b64 exec, s[82:83]
    ds_read_b128 v[24:27], v81 offset:18432
    ds_read_b128 v[28:31], v81 offset:18944
    s_mov_b64 exec, -1
    ds_read_b128 v[8:11], v80 offset:20480
    v_exp_f32 v34, v34
    v_exp_f32 v35, v35
    v_exp_f32 v36, v36
    s_waitcnt lgkmcnt(3)
    v_mfma_f32_32x32x16_bf16 v[48:63], v[12:15], v[4:7], 0
    v_exp_f32 v37, v37
    v_exp_f32 v38, v38
    v_exp_f32 v39, v39
    v_exp_f32 v40, v40
    v_exp_f32 v41, v41
    v_smfmac_f32_32x32x32_bf16 v[64:79], v[16:19], v[32:39], v3
    v_exp_f32 v42, v42
    v_exp_f32 v43, v43
    v_exp_f32 v44, v44
    v_exp_f32 v45, v45
    v_exp_f32 v46, v46
    v_exp_f32 v47, v47
    v_exp_f32 v48, v48
    v_exp_f32 v49, v49
    v_smfmac_f32_32x32x32_bf16 v[64:79], v[20:23], v[40:47], v3
    s_waitcnt vmcnt(0)
    ds_read_b128 v[144:147], v92 offset:0
    ds_read_b128 v[148:151], v92 offset:1024
    ds_read_b128 v[152:155], v92 offset:2048
    ds_read_b128 v[156:159], v92 offset:3072
    s_mov_b64 exec, s[82:83]
    ds_read_b128 v[16:19], v81 offset:20480
    ds_read_b128 v[20:23], v81 offset:20992
    s_mov_b64 exec, -1
    ds_read_b128 v[12:15], v80 offset:22528
    v_exp_f32 v50, v50
    v_exp_f32 v51, v51
    v_exp_f32 v52, v52
    s_waitcnt lgkmcnt(3)
    v_mfma_f32_32x32x16_bf16 v[32:47], v[8:11], v[4:7], 0
    v_exp_f32 v53, v53
    v_exp_f32 v54, v54
    v_exp_f32 v55, v55
    v_exp_f32 v56, v56
    v_exp_f32 v57, v57
    v_smfmac_f32_32x32x32_bf16 v[64:79], v[24:27], v[48:55], v3
    v_exp_f32 v58, v58
    v_exp_f32 v59, v59
    v_exp_f32 v60, v60
    v_exp_f32 v61, v61
    v_exp_f32 v62, v62
    v_exp_f32 v63, v63
    v_exp_f32 v32, v32
    v_exp_f32 v33, v33
    v_smfmac_f32_32x32x32_bf16 v[64:79], v[28:31], v[56:63], v3
    v_lshrrev_b32 v86, 4, v0
    v_and_b32 v87, 15, v0
    v_lshlrev_b32 v88, 14, v86
    v_lshl_add_u32 v88, v87, 1, v88
    s_lshl_b32 s90, s89, 16
    s_lshl_b32 s91, s88, 6
    s_add_u32 s90, s90, s91
    s_add_u32 s90, s90, 8388608
    buffer_load_short_d16_hi v160, v88, s[40:43], s90 offen offset:0 sc1
    buffer_load_short_d16_hi v164, v88, s[40:43], s90 offen offset:32 sc1
    s_add_u32 s90, s90, 4096
    buffer_load_short_d16_hi v161, v88, s[40:43], s90 offen offset:0 sc1
    buffer_load_short_d16_hi v165, v88, s[40:43], s90 offen offset:32 sc1
    s_add_u32 s90, s90, 4096
    buffer_load_short_d16_hi v162, v88, s[40:43], s90 offen offset:0 sc1
    buffer_load_short_d16_hi v166, v88, s[40:43], s90 offen offset:32 sc1
    s_add_u32 s90, s90, 4096
    buffer_load_short_d16_hi v163, v88, s[40:43], s90 offen offset:0 sc1
    buffer_load_short_d16_hi v167, v88, s[40:43], s90 offen offset:32 sc1
    v_lshlrev_b32 v88, 2, v87
    s_lshl_b32 s90, s88, 7
    s_add_u32 s90, s90, 13107200
    buffer_load_dword v168, v88, s[40:43], s90 offen sc1
    buffer_load_dword v169, v88, s[40:43], s90 offen offset:64 sc1
    s_mov_b64 exec, s[82:83]
    ds_read_b128 v[24:27], v81 offset:22528
    ds_read_b128 v[28:31], v81 offset:23040
    s_mov_b64 exec, -1
    ds_read_b128 v[8:11], v80 offset:24576
    v_exp_f32 v34, v34
    v_exp_f32 v35, v35
    v_exp_f32 v36, v36
    s_waitcnt lgkmcnt(3)
    v_mfma_f32_32x32x16_bf16 v[48:63], v[12:15], v[4:7], 0
    v_exp_f32 v37, v37
    v_exp_f32 v38, v38
    v_exp_f32 v39, v39
    v_exp_f32 v40, v40
    v_exp_f32 v41, v41
    v_smfmac_f32_32x32x32_bf16 v[64:79], v[16:19], v[32:39], v3
    v_exp_f32 v42, v42
    v_exp_f32 v43, v43
    v_exp_f32 v44, v44
    v_exp_f32 v45, v45
    v_exp_f32 v46, v46
    v_exp_f32 v47, v47
    s_cmp_ge_u32 s50, 4
    s_cbranch_scc1 L_pr59
    s_setprio 0
L_pr59:
    v_exp_f32 v48, v48
    v_exp_f32 v49, v49
    v_smfmac_f32_32x32x32_bf16 v[64:79], v[20:23], v[40:47], v3
    s_mov_b64 exec, s[82:83]
    ds_read_b128 v[16:19], v81 offset:24576
    ds_read_b128 v[20:23], v81 offset:25088
    s_mov_b64 exec, -1
    ds_read_b128 v[12:15], v80 offset:26624
    v_exp_f32 v50, v50
    v_exp_f32 v51, v51
    v_exp_f32 v52, v52
    s_waitcnt lgkmcnt(3)
    v_mfma_f32_32x32x16_bf16 v[32:47], v[8:11], v[4:7], 0
    v_exp_f32 v53, v53
    v_exp_f32 v54, v54
    v_exp_f32 v55, v55
    v_exp_f32 v56, v56
    v_exp_f32 v57, v57
    v_smfmac_f32_32x32x32_bf16 v[64:79], v[24:27], v[48:55], v3
    v_exp_f32 v58, v58
    v_exp_f32 v59, v59
    v_exp_f32 v60, v60
    v_exp_f32 v61, v61
    v_exp_f32 v62, v62
    v_exp_f32 v63, v63
    v_exp_f32 v32, v32
    v_exp_f32 v33, v33
    v_smfmac_f32_32x32x32_bf16 v[64:79], v[28:31], v[56:63], v3
    s_mov_b64 exec, s[82:83]
    ds_read_b128 v[24:27], v81 offset:26624
    ds_read_b128 v[28:31], v81 offset:27136
    s_mov_b64 exec, -1
    ds_read_b128 v[8:11], v80 offset:28672
    v_exp_f32 v34, v34
    v_exp_f32 v35, v35
    v_exp_f32 v36, v36
    s_waitcnt lgkmcnt(3)
    v_mfma_f32_32x32x16_bf16 v[48:63], v[12:15], v[4:7], 0
    v_exp_f32 v37, v37
    v_exp_f32 v38, v38
    v_exp_f32 v39, v39
    v_exp_f32 v40, v40
    v_exp_f32 v41, v41
    v_smfmac_f32_32x32x32_bf16 v[64:79], v[16:19], v[32:39], v3
    v_exp_f32 v42, v42
    v_exp_f32 v43, v43
    v_exp_f32 v44, v44
    v_exp_f32 v45, v45
    v_exp_f32 v46, v46
    v_exp_f32 v47, v47
    v_exp_f32 v48, v48
    v_exp_f32 v49, v49
    v_smfmac_f32_32x32x32_bf16 v[64:79], v[20:23], v[40:47], v3
    s_mov_b64 exec, s[82:83]
    ds_read_b128 v[16:19], v81 offset:28672
    ds_read_b128 v[20:23], v81 offset:29184
    s_mov_b64 exec, -1
    ds_read_b128 v[12:15], v80 offset:30720
    v_exp_f32 v50, v50
    v_exp_f32 v51, v51
    v_exp_f32 v52, v52
    s_waitcnt lgkmcnt(3)
    v_mfma_f32_32x32x16_bf16 v[32:47], v[8:11], v[4:7], 0
    v_exp_f32 v53, v53
    v_exp_f32 v54, v54
    v_exp_f32 v55, v55
    v_exp_f32 v56, v56
    v_exp_f32 v57, v57
    v_smfmac_f32_32x32x32_bf16 v[64:79], v[24:27], v[48:55], v3
    v_exp_f32 v58, v58
    v_exp_f32 v59, v59
    v_exp_f32 v60, v60
    v_exp_f32 v61, v61
    v_exp_f32 v62, v62
    v_exp_f32 v63, v63
    v_exp_f32 v32, v32
    v_exp_f32 v33, v33
    v_smfmac_f32_32x32x32_bf16 v[64:79], v[28:31], v[56:63], v3
    s_mov_b64 exec, s[82:83]
    ds_read_b128 v[24:27], v81 offset:30720
    ds_read_b128 v[28:31], v81 offset:31232
    s_mov_b64 exec, -1
    v_exp_f32 v34, v34
    v_exp_f32 v35, v35
    v_exp_f32 v36, v36
    s_waitcnt lgkmcnt(2)
    v_mfma_f32_32x32x16_bf16 v[48:63], v[12:15], v[4:7], 0
    v_exp_f32 v37, v37
    v_exp_f32 v38, v38
    v_exp_f32 v39, v39
    v_exp_f32 v40, v40
    v_exp_f32 v41, v41
    v_smfmac_f32_32x32x32_bf16 v[64:79], v[16:19], v[32:39], v3
    v_exp_f32 v42, v42
    v_exp_f32 v43, v43
    v_exp_f32 v44, v44
    v_exp_f32 v45, v45
    v_exp_f32 v46, v46
    v_exp_f32 v47, v47
    v_exp_f32 v48, v48
    v_exp_f32 v49, v49
    v_smfmac_f32_32x32x32_bf16 v[64:79], v[20:23], v[40:47], v3
    v_exp_f32 v50, v50
    v_exp_f32 v51, v51
    v_exp_f32 v52, v52
    s_waitcnt lgkmcnt(0)
    v_exp_f32 v53, v53
    v_exp_f32 v54, v54
    v_exp_f32 v55, v55
    v_exp_f32 v56, v56
    v_exp_f32 v57, v57
    v_smfmac_f32_32x32x32_bf16 v[64:79], v[24:27], v[48:55], v3
    v_exp_f32 v58, v58
    v_exp_f32 v59, v59
    v_exp_f32 v60, v60
    v_exp_f32 v61, v61
    v_exp_f32 v62, v62
    v_exp_f32 v63, v63
    s_nop 1
    v_smfmac_f32_32x32x32_bf16 v[64:79], v[28:31], v[56:63], v3
    s_mov_b32 s84, 0x2b800000
    s_mov_b32 s85, 0x5d800000
    s_nop 9
    v_fma_f32 v8, v64, 0, v72
    v_fma_f32 v8, v65, 0, v8
    v_fma_f32 v8, v66, 0, v8
    v_fma_f32 v8, v67, 0, v8
    v_fma_f32 v8, v68, 0, v8
    v_fma_f32 v8, v69, 0, v8
    v_fma_f32 v8, v70, 0, v8
    v_fma_f32 v8, v71, 0, v8
    v_cmp_nge_f32 vcc, v8, s84
    v_cmp_nle_f32 s[90:91], v8, s85
    s_nop 1
    s_or_b64 vcc, vcc, s[90:91]
    s_cbranch_vccnz L_at_slow
L_at_norm:
    v_rcp_f32 v8, v72
    s_nop 0
    v_mul_f32 v64, v8, v64
    v_mul_f32 v65, v8, v65
    v_mul_f32 v66, v8, v66
    v_mul_f32 v67, v8, v67
    v_mul_f32 v68, v8, v68
    v_mul_f32 v69, v8, v69
    v_mul_f32 v70, v8, v70
    v_mul_f32 v71, v8, v71
    v_cvt_pk_bf16_f32 v12, v64, v65
    v_cvt_pk_bf16_f32 v13, v66, v67
    v_cvt_pk_bf16_f32 v14, v68, v69
    v_cvt_pk_bf16_f32 v15, v70, v71
    v_min_u32 v12, -2, v12
    v_min_u32 v13, -2, v13
    v_min_u32 v14, -2, v14
    v_min_u32 v15, -2, v15
    buffer_store_dwordx4 v[12:15], v1, s[40:43], s87 offen sc1
    s_lshl_b32 s93, s88, 15
    s_lshl_b32 s86, s50, 12
    s_add_u32 s93, s93, s86
    s_add_u32 s93, s93, 10485760
    s_waitcnt vmcnt(1)
    s_mov_b32 s68, 0xffff0000
    v_sub_f32 v88, 1.0, v168
    v_sub_f32 v89, 1.0, v169
    v_cvt_pk_bf16_f32 v89, v88, v89
    v_lshlrev_b32 v88, 16, v89
    v_and_b32 v89, s68, v89
    v_mul_f32 v160, v88, v160
    v_mul_f32 v161, v88, v161
    v_mul_f32 v162, v88, v162
    v_mul_f32 v163, v88, v163
    v_cvt_pk_bf16_f32 v161, v160, v161
    v_lshlrev_b32 v160, 16, v161
    v_and_b32 v161, s68, v161
    v_cvt_pk_bf16_f32 v163, v162, v163
    v_lshlrev_b32 v162, 16, v163
    v_and_b32 v163, s68, v163
    v_mul_f32 v164, v89, v164
    v_mul_f32 v165, v89, v165
    v_mul_f32 v166, v89, v166
    v_mul_f32 v167, v89, v167
    v_cvt_pk_bf16_f32 v165, v164, v165
    v_lshlrev_b32 v164, 16, v165
    v_and_b32 v165, s68, v165
    v_cvt_pk_bf16_f32 v167, v166, v167
    v_lshlrev_b32 v166, 16, v167
    v_and_b32 v167, s68, v167
    v_lshlrev_b32 v2, 9, v86
    v_lshl_add_u32 v2, v87, 4, v2
    v_add_u32 v2, 131072, v2
    v_lshlrev_b32 v3, 10, v87
    v_lshl_add_u32 v3, v86, 3, v3
    s_lshl_b32 s84, s88, 15
    s_lshl_b32 s86, s89, 5
    s_add_u32 s84, s84, s86
    v_add_u32 v3, s84, v3
    v_add_u32 v4, 0x4000, v3
    s_mov_b32 s92, 400000
    s_waitcnt vmcnt(0)
    s_barrier
    s_branch L_o_go
L_o_again:
    s_sleep 1
L_o_go:
    buffer_load_dwordx4 v1, s[40:43], s93 offen offset:0 sc1 lds
    buffer_load_dwordx4 v1, s[40:43], s93 offen offset:1024 sc1 lds
    buffer_load_dwordx4 v1, s[40:43], s93 offen offset:2048 sc1 lds
    buffer_load_dwordx4 v1, s[40:43], s93 offen offset:3072 sc1 lds
L_o_chk:
    s_waitcnt vmcnt(0)
    ds_read_b128 v[16:19], v92 offset:0
    ds_read_b128 v[20:23], v92 offset:1024
    ds_read_b128 v[24:27], v92 offset:2048
    ds_read_b128 v[28:31], v92 offset:3072
    s_sub_u32 s92, s92, 1
    s_waitcnt lgkmcnt(2)
    v_max3_u32 v5, v16, v17, v18
    v_max3_u32 v6, v19, v20, v21
    v_max3_u32 v5, v22, v23, v5
    s_waitcnt lgkmcnt(0)
    v_max3_u32 v6, v24, v25, v6
    v_max3_u32 v5, v26, v27, v5
    v_max3_u32 v6, v28, v29, v6
    v_max3_u32 v5, v30, v31, v5
    v_max_u32 v5, v5, v6
    v_cmp_eq_u32 vcc, -1, v5
    s_cmp_eq_u32 s92, 0
    s_cbranch_scc1 L_o_ok
    s_cbranch_vccnz L_o_again
L_o_ok:
    s_barrier
    ds_read_b128 v[16:19], v2 offset:0
    ds_read_b128 v[20:23], v2 offset:256
    ds_read_b128 v[24:27], v2 offset:2048
    ds_read_b128 v[28:31], v2 offset:2304
    ds_read_b128 v[32:35], v2 offset:4096
    ds_read_b128 v[36:39], v2 offset:4352
    ds_read_b128 v[40:43], v2 offset:6144
    ds_read_b128 v[44:47], v2 offset:6400
    ds_read_b128 v[48:51], v2 offset:8192
    ds_read_b128 v[52:55], v2 offset:8448
    ds_read_b128 v[56:59], v2 offset:10240
    ds_read_b128 v[60:63], v2 offset:10496
    s_waitcnt lgkmcnt(8)
    v_mfma_f32_16x16x32_bf16 v[8:11], v[96:99], v[16:19], 0
    v_mfma_f32_16x16x32_bf16 v[12:15], v[96:99], v[20:23], 0
    v_mfma_f32_16x16x32_bf16 v[8:11], v[100:103], v[24:27], v[8:11]
    v_mfma_f32_16x16x32_bf16 v[12:15], v[100:103], v[28:31], v[12:15]
    ds_read_b128 v[16:19], v2 offset:12288
    ds_read_b128 v[20:23], v2 offset:12544
    ds_read_b128 v[24:27], v2 offset:14336
    ds_read_b128 v[28:31], v2 offset:14592
    s_waitcnt lgkmcnt(8)
    v_mfma_f32_16x16x32_bf16 v[8:11], v[104:107], v[32:35], v[8:11]
    v_mfma_f32_16x16x32_bf16 v[12:15], v[104:107], v[36:39], v[12:15]
    v_mfma_f32_16x16x32_bf16 v[8:11], v[108:111], v[40:43], v[8:11]
    v_mfma_f32_16x16x32_bf16 v[12:15], v[108:111], v[44:47], v[12:15]
    ds_read_b128 v[32:35], v2 offset:16384
    ds_read_b128 v[36:39], v2 offset:16640
    ds_read_b128 v[40:43], v2 offset:18432
    ds_read_b128 v[44:47], v2 offset:18688
    s_waitcnt lgkmcnt(8)
    v_mfma_f32_16x16x32_bf16 v[8:11], v[112:115], v[48:51], v[8:11]
    v_mfma_f32_16x16x32_bf16 v[12:15], v[112:115], v[52:55], v[12:15]
    v_mfma_f32_16x16x32_bf16 v[8:11], v[116:119], v[56:59], v[8:11]
    v_mfma_f32_16x16x32_bf16 v[12:15], v[116:119], v[60:63], v[12:15]
    ds_read_b128 v[48:51], v2 offset:20480
    ds_read_b128 v[52:55], v2 offset:20736
    ds_read_b128 v[56:59], v2 offset:22528
    ds_read_b128 v[60:63], v2 offset:22784
    s_waitcnt lgkmcnt(8)
    v_mfma_f32_16x16x32_bf16 v[8:11], v[120:123], v[16:19], v[8:11]
    v_mfma_f32_16x16x32_bf16 v[12:15], v[120:123], v[20:23], v[12:15]
    v_mfma_f32_16x16x32_bf16 v[8:11], v[124:127], v[24:27], v[8:11]
    v_mfma_f32_16x16x32_bf16 v[12:15], v[124:127], v[28:31], v[12:15]
    ds_read_b128 v[16:19], v2 offset:24576
    ds_read_b128 v[20:23], v2 offset:24832
    ds_read_b128 v[24:27], v2 offset:26624
    ds_read_b128 v[28:31], v2 offset:26880
    s_waitcnt lgkmcnt(8)
    v_mfma_f32_16x16x32_bf16 v[8:11], v[128:131], v[32:35], v[8:11]
    v_mfma_f32_16x16x32_bf16 v[12:15], v[128:131], v[36:39], v[12:15]
    v_mfma_f32_16x16x32_bf16 v[8:11], v[132:135], v[40:43], v[8:11]
    v_mfma_f32_16x16x32_bf16 v[12:15], v[132:135], v[44:47], v[12:15]
    ds_read_b128 v[32:35], v2 offset:28672
    ds_read_b128 v[36:39], v2 offset:28928
    ds_read_b128 v[40:43], v2 offset:30720
    ds_read_b128 v[44:47], v2 offset:30976
    s_waitcnt lgkmcnt(8)
    v_mfma_f32_16x16x32_bf16 v[8:11], v[136:139], v[48:51], v[8:11]
    v_mfma_f32_16x16x32_bf16 v[12:15], v[136:139], v[52:55], v[12:15]
    v_mfma_f32_16x16x32_bf16 v[8:11], v[140:143], v[56:59], v[8:11]
    v_mfma_f32_16x16x32_bf16 v[12:15], v[140:143], v[60:63], v[12:15]
    s_waitcnt lgkmcnt(4)
    v_mfma_f32_16x16x32_bf16 v[8:11], v[144:147], v[16:19], v[8:11]
    v_mfma_f32_16x16x32_bf16 v[12:15], v[144:147], v[20:23], v[12:15]
    v_mfma_f32_16x16x32_bf16 v[8:11], v[148:151], v[24:27], v[8:11]
    v_mfma_f32_16x16x32_bf16 v[12:15], v[148:151], v[28:31], v[12:15]
    s_waitcnt lgkmcnt(0)
    v_mfma_f32_16x16x32_bf16 v[8:11], v[152:155], v[32:35], v[8:11]
    v_mfma_f32_16x16x32_bf16 v[12:15], v[152:155], v[36:39], v[12:15]
    v_mfma_f32_16x16x32_bf16 v[8:11], v[156:159], v[40:43], v[8:11]
    v_mfma_f32_16x16x32_bf16 v[12:15], v[156:159], v[44:47], v[12:15]
    s_nop 6
    v_fma_f32 v8, v8, v168, v160
    v_fma_f32 v9, v9, v168, v161
    v_fma_f32 v10, v10, v168, v162
    v_fma_f32 v11, v11, v168, v163
    v_cvt_pk_bf16_f32 v16, v8, v9
    v_cvt_pk_bf16_f32 v17, v10, v11
    global_store_dwordx2 v3, v[16:17], s[26:27]
    v_fma_f32 v12, v12, v169, v164
    v_fma_f32 v13, v13, v169, v165
    v_fma_f32 v14, v14, v169, v166
    v_fma_f32 v15, v15, v169, v167
    v_cvt_pk_bf16_f32 v18, v12, v13
    v_cvt_pk_bf16_f32 v19, v14, v15
    global_store_dwordx2 v4, v[18:19], s[26:27]
L_end:
    s_endpgm
L_at_slow:
    v_mov_b32 v82, v1
    v_mov_b32 v84, 0xff800000
    s_mov_b32 s84, 64
L_at_slow1:
    ds_read_b128 v[8:11], v82
    v_add_u32 v82, 2048, v82
    s_waitcnt lgkmcnt(0)
    v_mfma_f32_32x32x16_bf16 v[32:47], v[8:11], v[4:7], 0
    s_nop 11
    v_max3_f32 v84, v32, v33, v84
    v_max3_f32 v84, v34, v35, v84
    v_max3_f32 v84, v36, v37, v84
    v_max3_f32 v84, v38, v39, v84
    v_max3_f32 v84, v40, v41, v84
    v_max3_f32 v84, v42, v43, v84
    v_max3_f32 v84, v44, v45, v84
    v_max3_f32 v84, v46, v47, v84
    s_sub_u32 s84, s84, 1
    s_cmp_lg_u32 s84, 0
    s_cbranch_scc1 L_at_slow1
    v_mov_b32 v85, v84
    s_nop 1
    v_permlane32_swap_b32 v84, v85
    v_max_f32 v84, v84, v85
    v_sub_f32 v48, 0, v84
    v_mov_b32 v64, 0
    v_sub_f32 v49, 0, v84
    v_mov_b32 v65, 0
    v_sub_f32 v50, 0, v84
    v_mov_b32 v66, 0
    v_sub_f32 v51, 0, v84
    v_mov_b32 v67, 0
    v_sub_f32 v52, 0, v84
    v_mov_b32 v68, 0
    v_sub_f32 v53, 0, v84
    v_mov_b32 v69, 0
    v_sub_f32 v54, 0, v84
    v_mov_b32 v70, 0
    v_sub_f32 v55, 0, v84
    v_mov_b32 v71, 0
    v_sub_f32 v56, 0, v84
    v_mov_b32 v72, 0
    v_sub_f32 v57, 0, v84
    v_mov_b32 v73, 0
    v_sub_f32 v58, 0, v84
    v_mov_b32 v74, 0
    v_sub_f32 v59, 0, v84
    v_mov_b32 v75, 0
    v_sub_f32 v60, 0, v84
    v_mov_b32 v76, 0
    v_sub_f32 v61, 0, v84
    v_mov_b32 v77, 0
    v_sub_f32 v62, 0, v84
    v_mov_b32 v78, 0
    v_sub_f32 v63, 0, v84
    v_mov_b32 v79, 0
    v_mov_b32 v82, v1
    v_mov_b32 v83, v2
    s_mov_b32 s84, 64
L_at_slow2:
    ds_read_b128 v[8:11], v82
    s_mov_b64 exec, s[82:83]
    ds_read_b128 v[16:19], v83
    ds_read_b128 v[20:23], v83 offset:512
    s_mov_b64 exec, -1
    v_add_u32 v82, 2048, v82
    v_add_u32 v83, 2048, v83
    s_waitcnt lgkmcnt(0)
    v_mfma_f32_32x32x16_bf16 v[32:47], v[8:11], v[4:7], v[48:63]
    s_nop 11
    v_exp_f32 v32, v32
    v_exp_f32 v33, v33
    v_exp_f32 v34, v34
    v_exp_f32 v35, v35
    v_exp_f32 v36, v36
    v_exp_f32 v37, v37
    v_exp_f32 v38, v38
    v_exp_f32 v39, v39
    v_exp_f32 v40, v40
    v_exp_f32 v41, v41
    v_exp_f32 v42, v42
    v_exp_f32 v43, v43
    v_exp_f32 v44, v44
    v_exp_f32 v45, v45
    v_exp_f32 v46, v46
    v_exp_f32 v47, v47
    v_smfmac_f32_32x32x32_bf16 v[64:79], v[16:19], v[32:39], v3
    s_nop 0
    v_smfmac_f32_32x32x32_bf16 v[64:79], v[20:23], v[40:47], v3
    s_sub_u32 s84, s84, 1
    s_cmp_lg_u32 s84, 0
    s_cbranch_scc1 L_at_slow2
    s_nop 15
    s_branch L_at_norm
L_codeend:
    s_endpgm
.section .rodata,"a"
.p2align 6
.amdhsa_kernel gated_mix__softmax_full_mha__ssm_conv_s4d__prompt_kernel
  .amdhsa_next_free_vgpr 256
  .amdhsa_next_free_sgpr 102
  .amdhsa_accum_offset 256
  .amdhsa_group_segment_fixed_size 0
  .amdhsa_kernarg_size 112
  .amdhsa_user_sgpr_count 2
  .amdhsa_user_sgpr_kernarg_segment_ptr 1
  .amdhsa_system_sgpr_workgroup_id_x 1
.end_amdhsa_kernel
```
